```python
import torch

def _softmax(x, axis=-1):
    return torch.softmax(x, dim=axis)
def _gelu(x):
    return torch.nn.functional.gelu(x, approximate="tanh")
def _silu(x):
    return torch.nn.functional.silu(x)
def _sigmoid(x):
    return torch.sigmoid(x)
def _layernorm(x, axis=-1, eps=1e-5):
    m = x.mean(dim=axis, keepdim=True)
    v = x.var(dim=axis, keepdim=True, unbiased=False)
    return (x - m) / torch.sqrt(v + eps)
def _scatter_add(tgt, idx, src, axis=0):
    return tgt.clone().index_add_(axis, idx, src)
def _segment_sum(src, seg, n):
    out = torch.zeros((n,) + src.shape[1:], dtype=src.dtype)
    return out.index_add_(0, seg, src)
def _pad(x, pw):
    flat = tuple(v for pair in reversed(pw) for v in pair)
    return torch.nn.functional.pad(x, flat)

kernel_name = 'sequential_preLN__linear_kernel_hedgehog__dense_activation_relu__prompt'

def setup_inputs():

    _w = (lambda a: (lambda t: t.to(torch.bfloat16) if t.is_floating_point() else t)(torch.as_tensor(a)))
    def _A_setup():
        B, S, D, H = 1, 2048, 640, 32
        Dh = D // H
        return {
            "x": _w((lambda *s: torch.randn(*s, dtype=torch.bfloat16) * 0.05)(B, S, D)),
            "wqkv": _w((lambda *s: torch.randn(*s, dtype=torch.bfloat16) * 0.2)(D, 3 * D)),
            "w_phi": _w((lambda *s: torch.randn(*s, dtype=torch.bfloat16) * 0.2)(H, Dh, Dh) * (Dh ** -0.5)),
            "wo": _w((lambda *s: torch.randn(*s, dtype=torch.bfloat16) * 0.05)(D, D)),
        }
    _A_in = _A_setup()

    def _B_setup():
        B, S, D, Dff = 1, 2048, 640, 1536
        return {
            "x": _w((lambda *s: torch.randn(*s, dtype=torch.bfloat16) * 0.05)(B, S, D)),
            "w1": _w((lambda *s: torch.randn(*s, dtype=torch.bfloat16) * 0.05)(D, Dff)),
            "w2": _w((lambda *s: torch.randn(*s, dtype=torch.bfloat16) * 0.05)(Dff, D)),
        }
    _B_in = _B_setup()

    return {
        "A_x": _A_in["x"],
        "A_wqkv": _A_in["wqkv"],
        "A_w_phi": _A_in["w_phi"],
        "A_wo": _A_in["wo"],
        "B_x": _B_in["x"],
        "B_w1": _B_in["w1"],
        "B_w2": _B_in["w2"],
    }

def reference(A_x, A_wqkv, A_w_phi, A_wo, B_x, B_w1, B_w2):
    def _A_ref(x, wqkv, w_phi, wo):
        B, S, D = x.shape
        H = 32; Dh = D // H
        qkv = (lambda x, *d: x.permute(*d))((x @ wqkv).reshape(B, S, 3, H, Dh), 2, 0, 3, 1, 4)
        q, k, v = qkv[0], qkv[1], qkv[2]
        pq = torch.einsum("bhsd,hdf->bhsf", q, w_phi)
        pk = torch.einsum("bhsd,hdf->bhsf", k, w_phi)
        phi_q = torch.concatenate([_softmax(pq, axis=-1), _softmax(-pq, axis=-1)], axis=-1)
        phi_k = torch.concatenate([_softmax(pk, axis=-1), _softmax(-pk, axis=-1)], axis=-1)
        kv = torch.einsum("bhsf,bhsd->bhfd", phi_k, v)
        z  = torch.einsum("bhsf->bhf", phi_k)
        num = torch.einsum("bhqf,bhfd->bhqd", phi_q, kv)
        den = torch.einsum("bhqf,bhf->bhq", phi_q, z)[..., None] + 1e-6
        o = num / den
        return (lambda x, *d: x.permute(*d))(o, 0, 2, 1, 3).reshape(B, S, D) @ wo

    def _B_ref(x, w1, w2):
        h = torch.einsum("bsd,df->bsf", x, w1)
        zero = torch.zeros_like(h)
        h = torch.maximum(h, zero)
        return torch.einsum("bsf,fd->bsd", h, w2)

    x = A_x
    h = x + _A_ref(_layernorm(x, axis=-1), A_wqkv, A_w_phi, A_wo)
    h2 = h + _B_ref(_layernorm(h, axis=-1), B_w1, B_w2)
    return h2
```

```asm
; @launch grid=(256,1,1) block=(256,1,1) lds=163840
.amdgcn_target "amdgcn-amd-amdhsa--gfx950"
.text
.globl sequential_preLN__linear_kernel_hedgehog__dense_activation_relu__prompt_kernel
.p2align 8
.type sequential_preLN__linear_kernel_hedgehog__dense_activation_relu__prompt_kernel,@function
sequential_preLN__linear_kernel_hedgehog__dense_activation_relu__prompt_kernel:
    s_cmp_ge_u32 s2, 256
    s_cbranch_scc1 L_end
    s_load_dwordx16 s[32:47], s[0:1], 0
    s_load_dwordx4 s[48:51], s[0:1], 64
    v_lshrrev_b32 v2, 6, v0
    v_and_b32 v1, 63, v0
    v_readfirstlane_b32 s3, v2
    v_lshlrev_b32 v11, 7, v1
    s_getpc_b64 s[28:29]
    s_and_b32 s28, s28, 0xffffff80
    s_mov_b32 s30, L_end-L_pc+256
    s_mov_b32 s31, 0x20000
L_pc:
    s_lshr_b32 s56, s2, 3
    s_lshl_b32 s56, s56, 2
    s_add_u32 s56, s56, s3
    s_lshl_b32 s56, s56, 7
    v_lshlrev_b32 v12, 14, v1
    s_mov_b64 exec, 7
    buffer_load_dword v12, v12, s[28:31], s56 offen
    s_mov_b64 exec, -1
    s_bfe_u32 s52, s2, 0x30003
    s_and_b32 s53, s2, 7
    s_lshl_b32 s53, s53, 2
    s_lshr_b32 s56, s2, 6
    s_add_u32 s53, s53, s56
    v_lshrrev_b32 v15, 3, v1
    v_and_b32 v16, 7, v1
    v_xor_b32 v14, v15, v16
    v_mul_u32_u24 v13, 1280, v15
    v_lshl_add_u32 v13, v14, 4, v13
    s_mul_i32 s56, s3, 20480
    s_mul_i32 s65, s53, 81920
    s_add_u32 s65, s65, s56
    s_and_b32 s57, s52, 3
    s_add_u32 s57, s57, 0
    s_and_b32 s57, s57, 3
    s_mul_i32 s76, s57, 5120
    s_add_u32 s76, s76, s56
    s_bitcmp1_b32 s57, 0
    s_cselect_b32 s72, 640, 0
    s_lshr_b32 s57, s57, 1
    s_mul_i32 s57, s57, 10240
    s_add_u32 s72, s72, s57
    s_add_u32 s72, s72, s65
    s_and_b32 s57, s52, 3
    s_add_u32 s57, s57, 1
    s_and_b32 s57, s57, 3
    s_mul_i32 s77, s57, 5120
    s_add_u32 s77, s77, s56
    s_bitcmp1_b32 s57, 0
    s_cselect_b32 s73, 640, 0
    s_lshr_b32 s57, s57, 1
    s_mul_i32 s57, s57, 10240
    s_add_u32 s73, s73, s57
    s_add_u32 s73, s73, s65
    s_and_b32 s57, s52, 3
    s_add_u32 s57, s57, 2
    s_and_b32 s57, s57, 3
    s_mul_i32 s78, s57, 5120
    s_add_u32 s78, s78, s56
    s_bitcmp1_b32 s57, 0
    s_cselect_b32 s74, 640, 0
    s_lshr_b32 s57, s57, 1
    s_mul_i32 s57, s57, 10240
    s_add_u32 s74, s74, s57
    s_add_u32 s74, s74, s65
    s_and_b32 s57, s52, 3
    s_add_u32 s57, s57, 3
    s_and_b32 s57, s57, 3
    s_mul_i32 s79, s57, 5120
    s_add_u32 s79, s79, s56
    s_bitcmp1_b32 s57, 0
    s_cselect_b32 s75, 640, 0
    s_lshr_b32 s57, s57, 1
    s_mul_i32 s57, s57, 10240
    s_add_u32 s75, s75, s57
    s_add_u32 s75, s75, s65
    s_waitcnt lgkmcnt(0)
    s_mov_b32 s4, s32
    s_mov_b32 s5, s33
    s_mov_b32 s6, 0x280000
    s_mov_b32 s7, 0x20000
    s_add_u32 m0, s76, 0
    s_nop 0
    buffer_load_dwordx4 v13, s[4:7], s72 offen offset:0 lds
    s_add_u32 m0, s76, 896
    s_nop 0
    buffer_load_dwordx4 v13, s[4:7], s72 offen offset:128 lds
    s_add_u32 m0, s76, 1792
    s_nop 0
    buffer_load_dwordx4 v13, s[4:7], s72 offen offset:256 lds
    s_add_u32 m0, s76, 2688
    s_nop 0
    buffer_load_dwordx4 v13, s[4:7], s72 offen offset:384 lds
    s_add_u32 m0, s76, 3584
    s_nop 0
    buffer_load_dwordx4 v13, s[4:7], s72 offen offset:512 lds
    s_add_u32 m0, s77, 0
    s_nop 0
    buffer_load_dwordx4 v13, s[4:7], s73 offen offset:0 lds
    s_add_u32 m0, s77, 896
    s_nop 0
    buffer_load_dwordx4 v13, s[4:7], s73 offen offset:128 lds
    s_add_u32 m0, s77, 1792
    s_nop 0
    buffer_load_dwordx4 v13, s[4:7], s73 offen offset:256 lds
    s_add_u32 m0, s77, 2688
    s_nop 0
    buffer_load_dwordx4 v13, s[4:7], s73 offen offset:384 lds
    s_add_u32 m0, s77, 3584
    s_nop 0
    buffer_load_dwordx4 v13, s[4:7], s73 offen offset:512 lds
    s_add_u32 s66, s50, 0xc48000
    s_addc_u32 s67, s51, 0
    s_load_dword s70, s[66:67], 0
    s_mov_b32 s8, s34
    s_mov_b32 s9, s35
    s_mov_b32 s10, 0x258000
    s_mov_b32 s11, 0x20000
    s_mov_b32 s24, s36
    s_mov_b32 s25, s37
    s_mov_b32 s26, 0x6400
    s_mov_b32 s27, 0x20000
    s_mov_b32 s20, s46
    s_mov_b32 s21, s47
    s_mov_b32 s22, 0x280000
    s_mov_b32 s23, 0x20000
    s_mov_b32 s12, s50
    s_mov_b32 s13, s51
    s_mov_b32 s14, 0x1900000
    s_mov_b32 s15, 0x20000
    v_lshrrev_b32 v2, 4, v1
    v_and_b32 v3, 15, v1
    v_bfe_u32 v4, v1, 2, 2
    v_and_b32 v5, 3, v1
    v_mov_b32 v6, 0
    v_lshlrev_b32 v8, 4, v1
    v_lshlrev_b32 v9, 3, v1
    v_lshlrev_b32 v10, 2, v1
    s_mov_b32 s68, 0x3fb8aa3b
    s_mov_b32 s69, 0x3fb8aa3b
    s_mul_i32 s58, s3, 5120
    s_lshl_b32 s61, s52, 2
    s_add_u32 s61, s61, s3
    s_lshl_b32 s62, s53, 5
    s_add_u32 s62, s62, s61
    v_lshlrev_b32 v14, 4, v0
    s_mul_i32 s56, s52, 3200
    v_add_u32 v14, s56, v14
    v_cmp_gt_u32 vcc, 200, v0
    v_mov_b32 v18, 0x40000000
    s_nop 0
    v_cndmask_b32 v14, v18, v14, vcc
    s_cmp_ge_u32 s2, 216
    s_cbranch_scc1 L_rl_2
    s_cmp_ge_u32 s2, 136
    s_cbranch_scc1 L_rl_5
    s_cmp_ge_u32 s2, 40
    s_cbranch_scc1 L_rl_1
    s_mov_b32 s80, 819200
    s_mul_i32 s56, s2, 205
    s_lshr_b32 s56, s56, 11
    s_mul_i32 s57, s56, 10
    s_sub_u32 s57, s2, s57
    s_and_b32 s90, s57, 1
    s_lshr_b32 s57, s57, 1
    s_mov_b32 s65, 40
    s_mov_b32 s81, 1280
    s_mul_i32 s84, s90, 640
    s_mov_b32 s86, 3072
    s_mov_b32 s87, 8
    s_mov_b32 s88, 160
    s_lshl_b32 s89, s90, 2
    s_add_u32 s89, s89, s3
    s_lshl_b32 s89, s89, 2
    s_add_u32 s89, s89, s56
    s_mul_i32 s89, s89, 5
    s_add_u32 s89, s89, s57
    s_mul_i32 s89, s89, 5120
    s_add_u32 s85, s89, 0x0
    s_branch L_rl_3
L_rl_1:
    s_mov_b32 s80, 1966080
    s_sub_u32 s89, s2, 40
    s_mul_i32 s56, s89, 171
    s_lshr_b32 s56, s56, 12
    s_mul_i32 s57, s56, 24
    s_sub_u32 s57, s89, s57
    s_and_b32 s90, s57, 1
    s_lshr_b32 s57, s57, 1
    s_mov_b32 s65, 40
    s_mov_b32 s81, 1280
    s_mul_i32 s84, s90, 640
    s_mov_b32 s86, 3072
    s_mov_b32 s87, 8
    s_mov_b32 s88, 160
    s_lshl_b32 s89, s90, 2
    s_add_u32 s89, s89, s3
    s_lshl_b32 s89, s89, 2
    s_add_u32 s89, s89, s56
    s_mul_i32 s89, s89, 12
    s_add_u32 s89, s89, s57
    s_mul_i32 s89, s89, 5120
    s_add_u32 s85, s89, 0x300000
    s_lshl_b32 s56, s56, 1
    s_cmp_ge_u32 s57, 6
    s_cselect_b32 s89, 6, 0
    s_addc_u32 s56, s56, 0
    s_sub_u32 s57, s57, s89
    s_mul_i32 s56, s56, 192
    s_mul_i32 s89, s57, 48
    s_mul_i32 s90, s57, 96
    s_sub_u32 s90, s90, 352
    s_cmp_ge_u32 s57, 4
    s_cselect_b32 s89, s90, s89
    s_cselect_b32 s83, 48, 16
    s_add_u32 s56, s56, s89
    s_lshl_b32 s89, s3, 2
    s_add_u32 s82, s56, s89
    s_branch L_rl_4
L_rl_5:
    s_mov_b32 s80, 2457600
    s_cmp_ge_u32 s2, 176
    s_cselect_b32 s56, 1, 0
    s_cselect_b32 s57, 40, 0
    s_sub_u32 s57, s2, s57
    s_sub_u32 s57, s57, 136
    s_and_b32 s90, s57, 1
    s_lshr_b32 s57, s57, 1
    s_mov_b32 s65, 40
    s_mov_b32 s81, 1280
    s_mul_i32 s84, s90, 640
    s_mov_b32 s86, 3072
    s_mov_b32 s87, 8
    s_mov_b32 s88, 160
    s_mov_b32 s81, 3840
    s_mov_b32 s83, 4
    s_mul_i32 s89, s56, -2560
    s_add_u32 s84, s84, s89
    s_add_u32 s84, s84, 2560
    s_lshl_b32 s89, s90, 2
    s_add_u32 s89, s89, s3
    s_mul_i32 s89, s89, 20
    s_add_u32 s89, s89, s57
    s_mul_i32 s89, s89, 5120
    s_lshl_b32 s56, s56, 20
    s_add_u32 s89, s89, s56
    s_add_u32 s85, s89, 0x500000
    s_lshl_b32 s57, s57, 2
    s_add_u32 s57, s57, s3
    s_lshl_b32 s82, s57, 3
    s_branch L_rl_4
L_rl_2:
    s_mov_b32 s80, 1966080
    s_sub_u32 s89, s2, 216
    s_and_b32 s90, s89, 3
    s_lshr_b32 s89, s89, 2
    s_mov_b32 s65, 8
    s_mov_b32 s81, 3072
    s_mul_i32 s84, s90, 768
    s_mov_b32 s86, 61440
    s_mov_b32 s87, 32
    s_mov_b32 s88, 192
    s_lshl_b32 s90, s90, 2
    s_add_u32 s90, s90, s3
    s_mul_i32 s90, s90, 40
    s_add_u32 s90, s90, s89
    s_mul_i32 s90, s90, 3072
    s_add_u32 s85, s90, 0x100000
    s_mul_i32 s56, s89, 205
    s_lshr_b32 s56, s56, 10
    s_mul_i32 s57, s56, 5
    s_sub_u32 s57, s89, s57
L_rl_3:
    s_mul_i32 s56, s56, 160
    s_lshl_b32 s89, s57, 3
    s_add_u32 s56, s56, s89
    s_cmp_ge_u32 s57, 3
    s_cselect_b32 s89, 56, 0
    s_add_u32 s56, s56, s89
    s_cmp_eq_u32 s57, 2
    s_cselect_b32 s83, 80, 4
    s_mul_i32 s89, s3, 20
    s_add_u32 s82, s56, s89
L_rl_4:
    v_lshrrev_b32 v17, 2, v15
    v_and_b32 v22, 3, v15
    v_mad_u32_u24 v17, v17, s83, v22
    v_add_u32 v17, s82, v17
    v_mul_u32_u24 v17, s81, v17
    v_lshl_add_u32 v23, v16, 4, v17
    s_cmp_eq_u32 s65, 40
    s_cselect_b32 s91, 0x40000000, s84
    s_mul_i32 s81, s3, 7168
    s_add_u32 s81, s81, 122880
    s_mul_i32 s56, s88, s3
    v_mul_u32_u24 v17, s65, v5
    v_add_u32 v17, s56, v17
    v_mul_u32_u24 v22, 7168, v2
    v_lshl_add_u32 v22, v4, 7, v22
    v_add_u32 v22, 122880, v22
    v_lshrrev_b32 v25, 7, v17
    v_mul_u32_u24 v25, 896, v25
    v_add3_u32 v25, v25, v17, v22
    v_add_u32 v17, s87, v17
    v_lshrrev_b32 v26, 7, v17
    v_mul_u32_u24 v26, 896, v26
    v_add3_u32 v26, v26, v17, v22
    v_add_u32 v17, s87, v17
    v_lshrrev_b32 v27, 7, v17
    v_mul_u32_u24 v27, 896, v27
    v_add3_u32 v27, v27, v17, v22
    v_add_u32 v17, s87, v17
    v_lshrrev_b32 v28, 7, v17
    v_mul_u32_u24 v28, 896, v28
    v_add3_u32 v28, v28, v17, v22
    v_add_u32 v17, s87, v17
    v_lshrrev_b32 v29, 7, v17
    v_mul_u32_u24 v29, 896, v29
    v_add3_u32 v29, v29, v17, v22
    v_add_u32 v17, s87, v17
    v_lshrrev_b32 v30, 7, v17
    v_mul_u32_u24 v30, 896, v30
    v_add3_u32 v30, v30, v17, v22
    s_lshl_b32 s56, s3, 5
    s_add_u32 s56, s56, 6144
    v_lshl_add_u32 v17, v5, 3, v22
    v_add_u32 v31, s56, v17
    s_add_u32 s86, s85, s86
    s_cmp_eq_u32 s65, 40
    s_cselect_b32 s87, 0x40000000, s86
    s_mul_i32 s90, s2, 171
    s_lshr_b32 s90, s90, 12
    s_mul_i32 s57, s90, 24
    s_sub_u32 s65, s2, s57
    s_add_u32 s90, s90, 10
    s_lshl_b32 s56, s65, 2
    s_add_u32 s56, s56, s3
    s_mul_i32 s57, s56, 171
    s_lshr_b32 s57, s57, 9
    s_mul_i32 s57, s57, 57
    s_add_u32 s56, s56, s57
    s_mul_i32 s57, s90, 3
    s_add_u32 s56, s56, s57
    s_lshl_b32 s56, s56, 10
    s_add_u32 s56, s56, 0x100000
    s_lshl_b32 s65, s65, 7
    s_cmp_ge_u32 s2, 240
    s_cselect_b32 s88, 0x40000000, s56
    s_cselect_b32 s65, 0x40000000, s65
    s_mul_i32 s56, s90, 205
    s_lshr_b32 s56, s56, 10
    s_mul_i32 s57, s56, 5
    s_sub_u32 s57, s90, s57
    s_mul_i32 s56, s56, 160
    s_lshl_b32 s89, s57, 3
    s_add_u32 s56, s56, s89
    s_cmp_ge_u32 s57, 3
    s_cselect_b32 s89, 56, 0
    s_add_u32 s56, s56, s89
    s_cmp_eq_u32 s57, 2
    s_cselect_b32 s83, 80, 4
    s_mul_i32 s89, s3, 20
    s_add_u32 s82, s56, s89
    v_lshrrev_b32 v17, 2, v15
    v_and_b32 v22, 3, v15
    v_mad_u32_u24 v17, v17, s83, v22
    v_add_u32 v17, s82, v17
    v_mul_u32_u24 v17, 3072, v17
    v_lshl_add_u32 v24, v16, 4, v17
    s_cmp_lt_u32 s2, 216
    s_cselect_b64 s[28:29], s[34:35], s[42:43]
    s_cmp_lt_u32 s2, 136
    s_cselect_b64 s[28:29], s[44:45], s[28:29]
    s_cmp_lt_u32 s2, 40
    s_cselect_b64 s[28:29], s[38:39], s[28:29]
    s_mov_b32 s16, s42
    s_mov_b32 s17, s43
    s_mov_b32 s18, 0x1e0000
    s_mov_b32 s19, 0x20000
    s_mov_b32 s30, s80
    s_mov_b32 s31, 0x20000
    s_add_u32 m0, s81, 0
    s_nop 0
    buffer_load_dwordx4 v23, s[28:31], s84 offen offset:0 nt lds
    s_add_u32 m0, s81, 896
    s_nop 0
    buffer_load_dwordx4 v23, s[28:31], s84 offen offset:128 nt lds
    s_add_u32 m0, s81, 1792
    s_nop 0
    buffer_load_dwordx4 v23, s[28:31], s84 offen offset:256 nt lds
    s_add_u32 m0, s81, 2688
    s_nop 0
    buffer_load_dwordx4 v23, s[28:31], s84 offen offset:384 nt lds
    s_add_u32 m0, s81, 3584
    s_nop 0
    buffer_load_dwordx4 v23, s[28:31], s84 offen offset:512 nt lds
    s_add_u32 m0, s81, 4480
    s_nop 0
    buffer_load_dwordx4 v23, s[28:31], s91 offen offset:640 nt lds
    s_add_u32 m0, s81, 6144
    s_nop 0
    buffer_load_dwordx4 v24, s[16:19], s65 offen nt lds
    s_lshl_b32 s56, s2, 2
    s_add_u32 s56, s56, s3
    s_mul_i32 s56, s56, 25
    s_lshr_b32 s56, s56, 2
    v_add_u32 v15, s56, v1
    v_mul_u32_u24 v12, 52429, v15
    v_lshrrev_b32 v12, 19, v12
    v_mul_u32_u24 v12, 2560, v12
    v_lshl_add_u32 v15, v15, 7, v12
    s_mov_b32 exec_lo, 0x7f
    s_mov_b32 exec_hi, 0x0
    buffer_load_dword v12, v15, s[8:11], 0 offen offset:1280
    s_mov_b64 exec, -1
    buffer_load_dwordx4 v[18:21], v14, s[24:27], 0 offen
    s_add_u32 m0, s78, 0
    s_nop 0
    buffer_load_dwordx4 v13, s[4:7], s74 offen offset:0 lds
    s_add_u32 m0, s78, 896
    s_nop 0
    buffer_load_dwordx4 v13, s[4:7], s74 offen offset:128 lds
    s_add_u32 m0, s78, 1792
    s_nop 0
    buffer_load_dwordx4 v13, s[4:7], s74 offen offset:256 lds
    s_add_u32 m0, s78, 2688
    s_nop 0
    buffer_load_dwordx4 v13, s[4:7], s74 offen offset:384 lds
    s_add_u32 m0, s78, 3584
    s_nop 0
    buffer_load_dwordx4 v13, s[4:7], s74 offen offset:512 lds
    s_add_u32 m0, s79, 0
    s_nop 0
    buffer_load_dwordx4 v13, s[4:7], s75 offen offset:0 lds
    s_add_u32 m0, s79, 896
    s_nop 0
    buffer_load_dwordx4 v13, s[4:7], s75 offen offset:128 lds
    s_add_u32 m0, s79, 1792
    s_nop 0
    buffer_load_dwordx4 v13, s[4:7], s75 offen offset:256 lds
    s_add_u32 m0, s79, 2688
    s_nop 0
    buffer_load_dwordx4 v13, s[4:7], s75 offen offset:384 lds
    s_add_u32 m0, s79, 3584
    s_nop 0
    buffer_load_dwordx4 v13, s[4:7], s75 offen offset:512 lds
    s_mul_i32 s56, s3, 20480
    v_lshrrev_b32 v15, 3, v3
    v_mul_u32_u24 v15, 10240, v15
    v_and_b32 v16, 7, v3
    v_lshl_add_u32 v15, v16, 7, v15
    v_add_u32 v15, s56, v15
    v_xor_b32 v13, v2, v16
    v_lshl_add_u32 v32, v13, 4, v15
    v_xor_b32 v33, 64, v32
    v_lshlrev_b32 v16, 4, v16
    s_and_b32 s63, s53, 1
    s_mul_i32 s56, s63, 6144
    s_mul_i32 s57, s63, -4096
    v_add_u32 v34, s57, v32
    v_add_u32 v35, s57, v33
    v_add_u32 v32, s56, v32
    v_add_u32 v33, s56, v33
    s_mul_i32 s56, s52, 160
    v_mad_u32_u24 v13, v2, 40, s56
    v_add_u32 v13, 0, v13
    v_lshrrev_b32 v36, 7, v13
    v_mul_u32_u24 v36, 896, v36
    v_xor_b32 v13, v13, v16
    v_add3_u32 v36, v36, v13, v15
    v_mad_u32_u24 v13, v2, 40, s56
    v_add_u32 v13, 8, v13
    v_lshrrev_b32 v37, 7, v13
    v_mul_u32_u24 v37, 896, v37
    v_xor_b32 v13, v13, v16
    v_add3_u32 v37, v37, v13, v15
    v_mad_u32_u24 v13, v2, 40, s56
    v_add_u32 v13, 16, v13
    v_lshrrev_b32 v38, 7, v13
    v_mul_u32_u24 v38, 896, v38
    v_xor_b32 v13, v13, v16
    v_add3_u32 v38, v38, v13, v15
    v_mad_u32_u24 v13, v2, 40, s56
    v_add_u32 v13, 24, v13
    v_lshrrev_b32 v39, 7, v13
    v_mul_u32_u24 v39, 896, v39
    v_xor_b32 v13, v13, v16
    v_add3_u32 v39, v39, v13, v15
    v_mad_u32_u24 v13, v2, 40, s56
    v_add_u32 v13, 32, v13
    v_lshrrev_b32 v40, 7, v13
    v_mul_u32_u24 v40, 896, v40
    v_xor_b32 v13, v13, v16
    v_add3_u32 v40, v40, v13, v15
    s_mul_i32 s59, s3, 122880
    s_mul_i32 s56, s52, 160
    s_add_u32 s59, s59, s56
    s_mul_i32 s56, s63, -983040
    s_add_u32 s64, s59, s56
    s_mul_i32 s56, s63, 1474560
    s_add_u32 s59, s59, s56
    v_add_u32 v13, 0, v1
    v_mul_u32_u24 v15, 6554, v13
    v_lshrrev_b32 v15, 16, v15
    v_mul_u32_u24 v41, 10, v15
    v_sub_u32 v13, v13, v41
    v_and_b32 v41, 0x13, v15
    v_bfe_u32 v16, v15, 2, 1
    v_lshl_or_b32 v41, v16, 3, v41
    v_bfe_u32 v16, v15, 3, 1
    v_lshl_or_b32 v41, v16, 2, v41
    v_mul_u32_u24 v41, 3840, v41
    v_lshl_add_u32 v41, v13, 4, v41
    v_add_u32 v13, 64, v1
    v_mul_u32_u24 v15, 6554, v13
    v_lshrrev_b32 v15, 16, v15
    v_mul_u32_u24 v42, 10, v15
    v_sub_u32 v13, v13, v42
    v_and_b32 v42, 0x13, v15
    v_bfe_u32 v16, v15, 2, 1
    v_lshl_or_b32 v42, v16, 3, v42
    v_bfe_u32 v16, v15, 3, 1
    v_lshl_or_b32 v42, v16, 2, v42
    v_mul_u32_u24 v42, 3840, v42
    v_lshl_add_u32 v42, v13, 4, v42
    v_add_u32 v13, 128, v1
    v_mul_u32_u24 v15, 6554, v13
    v_lshrrev_b32 v15, 16, v15
    v_mul_u32_u24 v43, 10, v15
    v_sub_u32 v13, v13, v43
    v_and_b32 v43, 0x13, v15
    v_bfe_u32 v16, v15, 2, 1
    v_lshl_or_b32 v43, v16, 3, v43
    v_bfe_u32 v16, v15, 3, 1
    v_lshl_or_b32 v43, v16, 2, v43
    v_mul_u32_u24 v43, 3840, v43
    v_lshl_add_u32 v43, v13, 4, v43
    v_add_u32 v13, 192, v1
    v_mul_u32_u24 v15, 6554, v13
    v_lshrrev_b32 v15, 16, v15
    v_mul_u32_u24 v44, 10, v15
    v_sub_u32 v13, v13, v44
    v_and_b32 v44, 0x13, v15
    v_bfe_u32 v16, v15, 2, 1
    v_lshl_or_b32 v44, v16, 3, v44
    v_bfe_u32 v16, v15, 3, 1
    v_lshl_or_b32 v44, v16, 2, v44
    v_mul_u32_u24 v44, 3840, v44
    v_lshl_add_u32 v44, v13, 4, v44
    v_add_u32 v13, 256, v1
    v_mul_u32_u24 v15, 6554, v13
    v_lshrrev_b32 v15, 16, v15
    v_mul_u32_u24 v45, 10, v15
    v_sub_u32 v13, v13, v45
    v_and_b32 v45, 0x13, v15
    v_bfe_u32 v16, v15, 2, 1
    v_lshl_or_b32 v45, v16, 3, v45
    v_bfe_u32 v16, v15, 3, 1
    v_lshl_or_b32 v45, v16, 2, v45
    v_mul_u32_u24 v45, 3840, v45
    v_lshl_add_u32 v45, v13, 4, v45
    v_mov_b32 v17, 0x40000000
    v_cmp_gt_u32 vcc, 41, v1
    s_nop 1
    v_cndmask_b32 v15, v17, v8, vcc
    v_cmp_gt_u32 vcc, 5, v1
    s_nop 1
    v_cndmask_b32 v16, v17, v8, vcc
    s_lshl_b32 s56, s52, 5
    s_add_u32 s56, s56, s53
    s_lshl_b32 s56, s56, 2
    s_add_u32 s56, s56, s3
    s_mul_i32 s56, s56, 1792
    s_add_u32 s72, s56, 0x700000
    s_and_b32 s56, s53, 7
    s_mul_i32 s56, s56, 3
    s_add_u32 s56, s56, s3
    s_mul_i32 s57, s56, 80
    s_cmp_ge_u32 s56, 21
    s_cselect_b32 s57, 0x40000000, s57
    s_cmp_eq_u32 s3, 3
    s_cselect_b32 s57, 0x40000000, s57
    s_lshr_b32 s56, s53, 3
    s_mul_i32 s56, s56, 1792
    s_add_u32 s73, s56, s57
    s_mul_i32 s56, s52, 7168
    s_add_u32 s56, s56, s73
    s_add_u32 s74, s56, 0xc00000
    v_lshrrev_b32 v13, 1, v2
    v_lshl_add_u32 v46, v13, 4, v4
    v_and_b32 v13, 1, v2
    v_lshl_add_u32 v13, v13, 2, v46
    v_mov_b32 v17, v13
    v_mul_u32_u24 v13, 160, v13
    v_mad_u32_u24 v46, v5, 40, v13
    v_add_u32 v47, 0x10000, v46
    v_add_u32 v48, 0x20000, v46
    v_mov_b32 v49, v8
    v_add_u32 v50, 0x10000, v8
    v_add_u32 v51, 0x20000, v8
    s_mul_i32 s75, s52, 102400
    s_add_u32 s75, s75, s58
    s_add_u32 s75, s75, 0x500000
    s_mul_i32 s56, s63, -40960
    s_add_u32 s76, s75, s56
    s_mul_i32 s56, s63, 61440
    s_add_u32 s75, s75, s56
    s_waitcnt lgkmcnt(0)
    s_add_u32 s70, s70, 1
    v_mov_b32 v7, s70
    s_lshl_b32 s56, s70, 16
    s_lshr_b32 s71, s70, 16
    s_or_b32 s71, s71, s56
    s_andn2_b32 s71, s71, 7
    s_waitcnt vmcnt(0)
    s_barrier
    ds_read_b64_tr_b16 v[142:143], v25
    ds_read_b64_tr_b16 v[144:145], v25 offset:512
    ds_read_b64_tr_b16 v[146:147], v26
    ds_read_b64_tr_b16 v[148:149], v26 offset:512
    ds_read_b64_tr_b16 v[150:151], v27
    ds_read_b64_tr_b16 v[152:153], v27 offset:512
    ds_read_b64_tr_b16 v[154:155], v28
    ds_read_b64_tr_b16 v[156:157], v28 offset:512
    ds_read_b64_tr_b16 v[158:159], v29
    ds_read_b64_tr_b16 v[160:161], v29 offset:512
    ds_read_b64_tr_b16 v[162:163], v30
    ds_read_b64_tr_b16 v[164:165], v30 offset:512
    ds_read_b64_tr_b16 v[166:167], v31
    ds_read_b64_tr_b16 v[168:169], v31 offset:512
    s_mul_i32 s56, s53, 384
    s_lshl_b32 s65, s61, 2
    s_add_u32 s56, s56, s65
    s_add_u32 s65, s56, 0xc40000
    v_mov_b32 v22, -1
    v_mov_b32 v23, -1
    v_mov_b32 v24, -1
    v_mov_b32 v25, -1
    s_add_u32 s60, s59, 1280
    s_add_u32 m0, s58, 81920
    s_nop 0
    buffer_load_dwordx4 v41, s[8:11], s60 offen lds
    s_add_u32 m0, s58, 82944
    s_nop 0
    buffer_load_dwordx4 v42, s[8:11], s60 offen lds
    s_add_u32 m0, s58, 83968
    s_nop 0
    buffer_load_dwordx4 v43, s[8:11], s60 offen lds
    s_add_u32 m0, s58, 84992
    s_nop 0
    buffer_load_dwordx4 v44, s[8:11], s60 offen lds
    s_add_u32 m0, s58, 86016
    s_nop 0
    buffer_load_dwordx4 v45, s[8:11], s60 offen lds
    ds_read_b128 v[52:55], v32 offset:0
    ds_read_b128 v[56:59], v33 offset:0
    ds_read_b128 v[60:63], v32 offset:1024
    ds_read_b128 v[64:67], v33 offset:1024
    ds_read_b128 v[68:71], v32 offset:2048
    ds_read_b128 v[72:75], v33 offset:2048
    ds_read_b128 v[76:79], v32 offset:3072
    ds_read_b128 v[80:83], v33 offset:3072
    ds_read_b128 v[84:87], v34 offset:4096
    ds_read_b128 v[88:91], v35 offset:4096
    ds_read_b128 v[92:95], v34 offset:5120
    ds_read_b128 v[96:99], v35 offset:5120
    ds_read_b128 v[100:103], v34 offset:6144
    ds_read_b128 v[104:107], v35 offset:6144
    ds_read_b128 v[108:111], v34 offset:7168
    ds_read_b128 v[112:115], v35 offset:7168
    ds_read_b128 v[116:119], v34 offset:8192
    ds_read_b128 v[120:123], v35 offset:8192
    ds_read_b128 v[124:127], v34 offset:9216
    ds_read_b128 v[128:131], v35 offset:9216
    ds_read_b64 v[132:133], v36 offset:0
    ds_read_b64 v[134:135], v37 offset:0
    ds_read_b64 v[136:137], v38 offset:0
    ds_read_b64 v[138:139], v39 offset:0
    ds_read_b64 v[140:141], v40 offset:0
    v_mov_b32 v13, 0
    v_mov_b32 v26, 0
    v_mov_b32 v27, 0x3f803f80
    s_waitcnt lgkmcnt(15)
    v_dot2c_f32_bf16 v13, v52, v27
    v_dot2c_f32_bf16 v26, v52, v52
    v_dot2c_f32_bf16 v13, v53, v27
    v_dot2c_f32_bf16 v26, v53, v53
    v_dot2c_f32_bf16 v13, v54, v27
    v_dot2c_f32_bf16 v26, v54, v54
    v_dot2c_f32_bf16 v13, v55, v27
    v_dot2c_f32_bf16 v26, v55, v55
    s_waitcnt lgkmcnt(15)
    v_dot2c_f32_bf16 v13, v56, v27
    v_dot2c_f32_bf16 v26, v56, v56
    v_dot2c_f32_bf16 v13, v57, v27
    v_dot2c_f32_bf16 v26, v57, v57
    v_dot2c_f32_bf16 v13, v58, v27
    v_dot2c_f32_bf16 v26, v58, v58
    v_dot2c_f32_bf16 v13, v59, v27
    v_dot2c_f32_bf16 v26, v59, v59
    s_waitcnt lgkmcnt(15)
    v_dot2c_f32_bf16 v13, v60, v27
    v_dot2c_f32_bf16 v26, v60, v60
    v_dot2c_f32_bf16 v13, v61, v27
    v_dot2c_f32_bf16 v26, v61, v61
    v_dot2c_f32_bf16 v13, v62, v27
    v_dot2c_f32_bf16 v26, v62, v62
    v_dot2c_f32_bf16 v13, v63, v27
    v_dot2c_f32_bf16 v26, v63, v63
    s_waitcnt lgkmcnt(15)
    v_dot2c_f32_bf16 v13, v64, v27
    v_dot2c_f32_bf16 v26, v64, v64
    v_dot2c_f32_bf16 v13, v65, v27
    v_dot2c_f32_bf16 v26, v65, v65
    v_dot2c_f32_bf16 v13, v66, v27
    v_dot2c_f32_bf16 v26, v66, v66
    v_dot2c_f32_bf16 v13, v67, v27
    v_dot2c_f32_bf16 v26, v67, v67
    s_waitcnt lgkmcnt(15)
    v_dot2c_f32_bf16 v13, v68, v27
    v_dot2c_f32_bf16 v26, v68, v68
    v_dot2c_f32_bf16 v13, v69, v27
    v_dot2c_f32_bf16 v26, v69, v69
    v_dot2c_f32_bf16 v13, v70, v27
    v_dot2c_f32_bf16 v26, v70, v70
    v_dot2c_f32_bf16 v13, v71, v27
    v_dot2c_f32_bf16 v26, v71, v71
    s_waitcnt lgkmcnt(15)
    v_dot2c_f32_bf16 v13, v72, v27
    v_dot2c_f32_bf16 v26, v72, v72
    v_dot2c_f32_bf16 v13, v73, v27
    v_dot2c_f32_bf16 v26, v73, v73
    v_dot2c_f32_bf16 v13, v74, v27
    v_dot2c_f32_bf16 v26, v74, v74
    v_dot2c_f32_bf16 v13, v75, v27
    v_dot2c_f32_bf16 v26, v75, v75
    buffer_store_dwordx4 v[142:145], v8, s[12:15], s85 offen offset:0 sc1
    s_waitcnt lgkmcnt(15)
    v_dot2c_f32_bf16 v13, v76, v27
    v_dot2c_f32_bf16 v26, v76, v76
    v_dot2c_f32_bf16 v13, v77, v27
    v_dot2c_f32_bf16 v26, v77, v77
    v_dot2c_f32_bf16 v13, v78, v27
    v_dot2c_f32_bf16 v26, v78, v78
    v_dot2c_f32_bf16 v13, v79, v27
    v_dot2c_f32_bf16 v26, v79, v79
    s_waitcnt lgkmcnt(15)
    v_dot2c_f32_bf16 v13, v80, v27
    v_dot2c_f32_bf16 v26, v80, v80
    v_dot2c_f32_bf16 v13, v81, v27
    v_dot2c_f32_bf16 v26, v81, v81
    v_dot2c_f32_bf16 v13, v82, v27
    v_dot2c_f32_bf16 v26, v82, v82
    v_dot2c_f32_bf16 v13, v83, v27
    v_dot2c_f32_bf16 v26, v83, v83
    s_waitcnt lgkmcnt(15)
    v_dot2c_f32_bf16 v13, v84, v27
    v_dot2c_f32_bf16 v26, v84, v84
    v_dot2c_f32_bf16 v13, v85, v27
    v_dot2c_f32_bf16 v26, v85, v85
    v_dot2c_f32_bf16 v13, v86, v27
    v_dot2c_f32_bf16 v26, v86, v86
    v_dot2c_f32_bf16 v13, v87, v27
    v_dot2c_f32_bf16 v26, v87, v87
    s_waitcnt lgkmcnt(15)
    v_dot2c_f32_bf16 v13, v88, v27
    v_dot2c_f32_bf16 v26, v88, v88
    buffer_store_dwordx4 v[146:149], v8, s[12:15], s85 offen offset:1024 sc1
    v_dot2c_f32_bf16 v13, v89, v27
    v_dot2c_f32_bf16 v26, v89, v89
    v_dot2c_f32_bf16 v13, v90, v27
    v_dot2c_f32_bf16 v26, v90, v90
    v_dot2c_f32_bf16 v13, v91, v27
    v_dot2c_f32_bf16 v26, v91, v91
    s_waitcnt lgkmcnt(14)
    v_dot2c_f32_bf16 v13, v92, v27
    v_dot2c_f32_bf16 v26, v92, v92
    v_dot2c_f32_bf16 v13, v93, v27
    v_dot2c_f32_bf16 v26, v93, v93
    v_dot2c_f32_bf16 v13, v94, v27
    v_dot2c_f32_bf16 v26, v94, v94
    v_dot2c_f32_bf16 v13, v95, v27
    v_dot2c_f32_bf16 v26, v95, v95
    s_waitcnt lgkmcnt(13)
    v_dot2c_f32_bf16 v13, v96, v27
    v_dot2c_f32_bf16 v26, v96, v96
    v_dot2c_f32_bf16 v13, v97, v27
    v_dot2c_f32_bf16 v26, v97, v97
    v_dot2c_f32_bf16 v13, v98, v27
    v_dot2c_f32_bf16 v26, v98, v98
    v_dot2c_f32_bf16 v13, v99, v27
    v_dot2c_f32_bf16 v26, v99, v99
    s_waitcnt lgkmcnt(12)
    v_dot2c_f32_bf16 v13, v100, v27
    v_dot2c_f32_bf16 v26, v100, v100
    v_dot2c_f32_bf16 v13, v101, v27
    v_dot2c_f32_bf16 v26, v101, v101
    buffer_store_dwordx4 v[150:153], v8, s[12:15], s85 offen offset:2048 sc1
    v_dot2c_f32_bf16 v13, v102, v27
    v_dot2c_f32_bf16 v26, v102, v102
    v_dot2c_f32_bf16 v13, v103, v27
    v_dot2c_f32_bf16 v26, v103, v103
    s_waitcnt lgkmcnt(11)
    v_dot2c_f32_bf16 v13, v104, v27
    v_dot2c_f32_bf16 v26, v104, v104
    v_dot2c_f32_bf16 v13, v105, v27
    v_dot2c_f32_bf16 v26, v105, v105
    v_dot2c_f32_bf16 v13, v106, v27
    v_dot2c_f32_bf16 v26, v106, v106
    v_dot2c_f32_bf16 v13, v107, v27
    v_dot2c_f32_bf16 v26, v107, v107
    s_waitcnt lgkmcnt(10)
    v_dot2c_f32_bf16 v13, v108, v27
    v_dot2c_f32_bf16 v26, v108, v108
    v_dot2c_f32_bf16 v13, v109, v27
    v_dot2c_f32_bf16 v26, v109, v109
    v_dot2c_f32_bf16 v13, v110, v27
    v_dot2c_f32_bf16 v26, v110, v110
    v_dot2c_f32_bf16 v13, v111, v27
    v_dot2c_f32_bf16 v26, v111, v111
    s_waitcnt lgkmcnt(9)
    v_dot2c_f32_bf16 v13, v112, v27
    v_dot2c_f32_bf16 v26, v112, v112
    v_dot2c_f32_bf16 v13, v113, v27
    v_dot2c_f32_bf16 v26, v113, v113
    buffer_store_dwordx4 v[154:157], v8, s[12:15], s86 offen offset:0 sc1
    v_dot2c_f32_bf16 v13, v114, v27
    v_dot2c_f32_bf16 v26, v114, v114
    v_dot2c_f32_bf16 v13, v115, v27
    v_dot2c_f32_bf16 v26, v115, v115
    s_waitcnt lgkmcnt(8)
    v_dot2c_f32_bf16 v13, v116, v27
    v_dot2c_f32_bf16 v26, v116, v116
    v_dot2c_f32_bf16 v13, v117, v27
    v_dot2c_f32_bf16 v26, v117, v117
    v_dot2c_f32_bf16 v13, v118, v27
    v_dot2c_f32_bf16 v26, v118, v118
    v_dot2c_f32_bf16 v13, v119, v27
    v_dot2c_f32_bf16 v26, v119, v119
    s_waitcnt lgkmcnt(7)
    v_dot2c_f32_bf16 v13, v120, v27
    v_dot2c_f32_bf16 v26, v120, v120
    v_dot2c_f32_bf16 v13, v121, v27
    v_dot2c_f32_bf16 v26, v121, v121
    v_dot2c_f32_bf16 v13, v122, v27
    v_dot2c_f32_bf16 v26, v122, v122
    v_dot2c_f32_bf16 v13, v123, v27
    v_dot2c_f32_bf16 v26, v123, v123
    s_waitcnt lgkmcnt(6)
    v_dot2c_f32_bf16 v13, v124, v27
    v_dot2c_f32_bf16 v26, v124, v124
    v_dot2c_f32_bf16 v13, v125, v27
    v_dot2c_f32_bf16 v26, v125, v125
    v_dot2c_f32_bf16 v13, v126, v27
    v_dot2c_f32_bf16 v26, v126, v126
    buffer_store_dwordx4 v[158:161], v8, s[12:15], s86 offen offset:1024 sc1
    v_dot2c_f32_bf16 v13, v127, v27
    v_dot2c_f32_bf16 v26, v127, v127
    s_waitcnt lgkmcnt(5)
    v_dot2c_f32_bf16 v13, v128, v27
    v_dot2c_f32_bf16 v26, v128, v128
    v_dot2c_f32_bf16 v13, v129, v27
    v_dot2c_f32_bf16 v26, v129, v129
    v_dot2c_f32_bf16 v13, v130, v27
    v_dot2c_f32_bf16 v26, v130, v130
    v_dot2c_f32_bf16 v13, v131, v27
    v_dot2c_f32_bf16 v26, v131, v131
    s_nop 2
    v_permlane32_swap_b32 v13, v26
    v_add_f32 v13, v13, v26
    v_mov_b32 v28, v13
    s_nop 1
    v_permlane16_swap_b32 v13, v28
    v_add_f32 v13, v13, v28
    v_mov_b32 v26, v13
    s_nop 1
    v_permlane32_swap_b32 v13, v26
    v_mul_f32 v13, 0x3acccccd, v13
    v_mul_f32 v26, 0x3acccccd, v26
    v_fma_f32 v26, -v13, v13, v26
    v_max_f32 v26, 0, v26
    v_add_f32 v26, 0x3727c5ac, v26
    v_rsq_f32 v28, v26
    s_nop 0
    v_mul_f32 v29, v13, v28
    v_sub_f32 v29, 0, v29
    v_lshlrev_b32 v30, 16, v52
    v_and_b32 v31, 0xffff0000, v52
    v_pk_fma_f32 v[30:31], v[30:31], v[28:29], v[28:29] op_sel:[0,0,1] op_sel_hi:[1,0,1]
    v_cvt_pk_bf16_f32 v52, v30, v31
    buffer_store_dwordx4 v[162:165], v8, s[12:15], s87 offen offset:2048 sc1
    v_lshlrev_b32 v32, 16, v53
    v_and_b32 v33, 0xffff0000, v53
    v_pk_fma_f32 v[32:33], v[32:33], v[28:29], v[28:29] op_sel:[0,0,1] op_sel_hi:[1,0,1]
    v_cvt_pk_bf16_f32 v53, v32, v33
    v_lshlrev_b32 v34, 16, v54
    v_and_b32 v35, 0xffff0000, v54
    v_pk_fma_f32 v[34:35], v[34:35], v[28:29], v[28:29] op_sel:[0,0,1] op_sel_hi:[1,0,1]
    v_cvt_pk_bf16_f32 v54, v34, v35
    v_lshlrev_b32 v36, 16, v55
    v_and_b32 v37, 0xffff0000, v55
    v_pk_fma_f32 v[36:37], v[36:37], v[28:29], v[28:29] op_sel:[0,0,1] op_sel_hi:[1,0,1]
    v_cvt_pk_bf16_f32 v55, v36, v37
    v_lshlrev_b32 v30, 16, v56
    v_and_b32 v31, 0xffff0000, v56
    v_pk_fma_f32 v[30:31], v[30:31], v[28:29], v[28:29] op_sel:[0,0,1] op_sel_hi:[1,0,1]
    v_cvt_pk_bf16_f32 v56, v30, v31
    v_lshlrev_b32 v32, 16, v57
    v_and_b32 v33, 0xffff0000, v57
    v_pk_fma_f32 v[32:33], v[32:33], v[28:29], v[28:29] op_sel:[0,0,1] op_sel_hi:[1,0,1]
    v_cvt_pk_bf16_f32 v57, v32, v33
    buffer_store_dwordx4 v[166:169], v8, s[12:15], s88 offen offset:0 sc1
    v_lshlrev_b32 v34, 16, v58
    v_and_b32 v35, 0xffff0000, v58
    v_pk_fma_f32 v[34:35], v[34:35], v[28:29], v[28:29] op_sel:[0,0,1] op_sel_hi:[1,0,1]
    v_cvt_pk_bf16_f32 v58, v34, v35
    v_lshlrev_b32 v36, 16, v59
    v_and_b32 v37, 0xffff0000, v59
    v_pk_fma_f32 v[36:37], v[36:37], v[28:29], v[28:29] op_sel:[0,0,1] op_sel_hi:[1,0,1]
    v_cvt_pk_bf16_f32 v59, v36, v37
    v_lshlrev_b32 v30, 16, v60
    v_and_b32 v31, 0xffff0000, v60
    v_pk_fma_f32 v[30:31], v[30:31], v[28:29], v[28:29] op_sel:[0,0,1] op_sel_hi:[1,0,1]
    v_cvt_pk_bf16_f32 v60, v30, v31
    v_lshlrev_b32 v32, 16, v61
    v_and_b32 v33, 0xffff0000, v61
    v_pk_fma_f32 v[32:33], v[32:33], v[28:29], v[28:29] op_sel:[0,0,1] op_sel_hi:[1,0,1]
    v_cvt_pk_bf16_f32 v61, v32, v33
    v_lshlrev_b32 v34, 16, v62
    v_and_b32 v35, 0xffff0000, v62
    v_pk_fma_f32 v[34:35], v[34:35], v[28:29], v[28:29] op_sel:[0,0,1] op_sel_hi:[1,0,1]
    v_cvt_pk_bf16_f32 v62, v34, v35
    v_lshlrev_b32 v36, 16, v63
    v_and_b32 v37, 0xffff0000, v63
    v_pk_fma_f32 v[36:37], v[36:37], v[28:29], v[28:29] op_sel:[0,0,1] op_sel_hi:[1,0,1]
    v_cvt_pk_bf16_f32 v63, v36, v37
    buffer_store_dwordx4 v[22:25], v8, s[12:15], s72 offen sc1
    v_lshlrev_b32 v30, 16, v64
    v_and_b32 v31, 0xffff0000, v64
    v_pk_fma_f32 v[30:31], v[30:31], v[28:29], v[28:29] op_sel:[0,0,1] op_sel_hi:[1,0,1]
    v_cvt_pk_bf16_f32 v64, v30, v31
    v_lshlrev_b32 v32, 16, v65
    v_and_b32 v33, 0xffff0000, v65
    v_pk_fma_f32 v[32:33], v[32:33], v[28:29], v[28:29] op_sel:[0,0,1] op_sel_hi:[1,0,1]
    v_cvt_pk_bf16_f32 v65, v32, v33
    v_lshlrev_b32 v34, 16, v66
    v_and_b32 v35, 0xffff0000, v66
    v_pk_fma_f32 v[34:35], v[34:35], v[28:29], v[28:29] op_sel:[0,0,1] op_sel_hi:[1,0,1]
    v_cvt_pk_bf16_f32 v66, v34, v35
    v_lshlrev_b32 v36, 16, v67
    v_and_b32 v37, 0xffff0000, v67
    v_pk_fma_f32 v[36:37], v[36:37], v[28:29], v[28:29] op_sel:[0,0,1] op_sel_hi:[1,0,1]
    v_cvt_pk_bf16_f32 v67, v36, v37
    v_lshlrev_b32 v30, 16, v68
    v_and_b32 v31, 0xffff0000, v68
    v_pk_fma_f32 v[30:31], v[30:31], v[28:29], v[28:29] op_sel:[0,0,1] op_sel_hi:[1,0,1]
    v_cvt_pk_bf16_f32 v68, v30, v31
    v_lshlrev_b32 v32, 16, v69
    v_and_b32 v33, 0xffff0000, v69
    v_pk_fma_f32 v[32:33], v[32:33], v[28:29], v[28:29] op_sel:[0,0,1] op_sel_hi:[1,0,1]
    v_cvt_pk_bf16_f32 v69, v32, v33
    v_lshlrev_b32 v34, 16, v70
    v_and_b32 v35, 0xffff0000, v70
    v_pk_fma_f32 v[34:35], v[34:35], v[28:29], v[28:29] op_sel:[0,0,1] op_sel_hi:[1,0,1]
    v_cvt_pk_bf16_f32 v70, v34, v35
    buffer_store_dwordx4 v[22:25], v15, s[12:15], s72 offen offset:1024 sc1
    v_lshlrev_b32 v36, 16, v71
    v_and_b32 v37, 0xffff0000, v71
    v_pk_fma_f32 v[36:37], v[36:37], v[28:29], v[28:29] op_sel:[0,0,1] op_sel_hi:[1,0,1]
    v_cvt_pk_bf16_f32 v71, v36, v37
    v_lshlrev_b32 v30, 16, v72
    v_and_b32 v31, 0xffff0000, v72
    v_pk_fma_f32 v[30:31], v[30:31], v[28:29], v[28:29] op_sel:[0,0,1] op_sel_hi:[1,0,1]
    v_cvt_pk_bf16_f32 v72, v30, v31
    v_lshlrev_b32 v32, 16, v73
    v_and_b32 v33, 0xffff0000, v73
    v_pk_fma_f32 v[32:33], v[32:33], v[28:29], v[28:29] op_sel:[0,0,1] op_sel_hi:[1,0,1]
    v_cvt_pk_bf16_f32 v73, v32, v33
    v_lshlrev_b32 v34, 16, v74
    v_and_b32 v35, 0xffff0000, v74
    v_pk_fma_f32 v[34:35], v[34:35], v[28:29], v[28:29] op_sel:[0,0,1] op_sel_hi:[1,0,1]
    v_cvt_pk_bf16_f32 v74, v34, v35
    v_lshlrev_b32 v36, 16, v75
    v_and_b32 v37, 0xffff0000, v75
    v_pk_fma_f32 v[36:37], v[36:37], v[28:29], v[28:29] op_sel:[0,0,1] op_sel_hi:[1,0,1]
    v_cvt_pk_bf16_f32 v75, v36, v37
    v_lshlrev_b32 v30, 16, v76
    v_and_b32 v31, 0xffff0000, v76
    v_pk_fma_f32 v[30:31], v[30:31], v[28:29], v[28:29] op_sel:[0,0,1] op_sel_hi:[1,0,1]
    v_cvt_pk_bf16_f32 v76, v30, v31
    buffer_store_dwordx4 v[22:25], v16, s[12:15], s74 offen sc1
    v_lshlrev_b32 v32, 16, v77
    v_and_b32 v33, 0xffff0000, v77
    v_pk_fma_f32 v[32:33], v[32:33], v[28:29], v[28:29] op_sel:[0,0,1] op_sel_hi:[1,0,1]
    v_cvt_pk_bf16_f32 v77, v32, v33
    v_lshlrev_b32 v34, 16, v78
    v_and_b32 v35, 0xffff0000, v78
    v_pk_fma_f32 v[34:35], v[34:35], v[28:29], v[28:29] op_sel:[0,0,1] op_sel_hi:[1,0,1]
    v_cvt_pk_bf16_f32 v78, v34, v35
    v_lshlrev_b32 v36, 16, v79
    v_and_b32 v37, 0xffff0000, v79
    v_pk_fma_f32 v[36:37], v[36:37], v[28:29], v[28:29] op_sel:[0,0,1] op_sel_hi:[1,0,1]
    v_cvt_pk_bf16_f32 v79, v36, v37
    v_lshlrev_b32 v30, 16, v80
    v_and_b32 v31, 0xffff0000, v80
    v_pk_fma_f32 v[30:31], v[30:31], v[28:29], v[28:29] op_sel:[0,0,1] op_sel_hi:[1,0,1]
    v_cvt_pk_bf16_f32 v80, v30, v31
    v_lshlrev_b32 v32, 16, v81
    v_and_b32 v33, 0xffff0000, v81
    v_pk_fma_f32 v[32:33], v[32:33], v[28:29], v[28:29] op_sel:[0,0,1] op_sel_hi:[1,0,1]
    v_cvt_pk_bf16_f32 v81, v32, v33
    v_lshlrev_b32 v34, 16, v82
    v_and_b32 v35, 0xffff0000, v82
    v_pk_fma_f32 v[34:35], v[34:35], v[28:29], v[28:29] op_sel:[0,0,1] op_sel_hi:[1,0,1]
    v_cvt_pk_bf16_f32 v82, v34, v35
    s_mov_b64 exec, 7
    buffer_load_dword v12, v11, s[12:15], s65 offen sc1
    s_mov_b64 exec, -1
    v_lshlrev_b32 v36, 16, v83
    v_and_b32 v37, 0xffff0000, v83
    v_pk_fma_f32 v[36:37], v[36:37], v[28:29], v[28:29] op_sel:[0,0,1] op_sel_hi:[1,0,1]
    v_cvt_pk_bf16_f32 v83, v36, v37
    v_lshlrev_b32 v30, 16, v84
    v_and_b32 v31, 0xffff0000, v84
    v_pk_fma_f32 v[30:31], v[30:31], v[28:29], v[28:29] op_sel:[0,0,1] op_sel_hi:[1,0,1]
    v_cvt_pk_bf16_f32 v84, v30, v31
    v_lshlrev_b32 v32, 16, v85
    v_and_b32 v33, 0xffff0000, v85
    v_pk_fma_f32 v[32:33], v[32:33], v[28:29], v[28:29] op_sel:[0,0,1] op_sel_hi:[1,0,1]
    v_cvt_pk_bf16_f32 v85, v32, v33
    v_lshlrev_b32 v34, 16, v86
    v_and_b32 v35, 0xffff0000, v86
    v_pk_fma_f32 v[34:35], v[34:35], v[28:29], v[28:29] op_sel:[0,0,1] op_sel_hi:[1,0,1]
    v_cvt_pk_bf16_f32 v86, v34, v35
    v_lshlrev_b32 v36, 16, v87
    v_and_b32 v37, 0xffff0000, v87
    v_pk_fma_f32 v[36:37], v[36:37], v[28:29], v[28:29] op_sel:[0,0,1] op_sel_hi:[1,0,1]
    v_cvt_pk_bf16_f32 v87, v36, v37
    v_lshlrev_b32 v30, 16, v88
    v_and_b32 v31, 0xffff0000, v88
    v_pk_fma_f32 v[30:31], v[30:31], v[28:29], v[28:29] op_sel:[0,0,1] op_sel_hi:[1,0,1]
    v_cvt_pk_bf16_f32 v88, v30, v31
    s_add_u32 s60, s59, 492800
    s_add_u32 m0, s58, 102400
    s_nop 0
    buffer_load_dwordx4 v41, s[8:11], s60 offen lds
    v_lshlrev_b32 v32, 16, v89
    v_and_b32 v33, 0xffff0000, v89
    v_pk_fma_f32 v[32:33], v[32:33], v[28:29], v[28:29] op_sel:[0,0,1] op_sel_hi:[1,0,1]
    v_cvt_pk_bf16_f32 v89, v32, v33
    v_lshlrev_b32 v34, 16, v90
    v_and_b32 v35, 0xffff0000, v90
    v_pk_fma_f32 v[34:35], v[34:35], v[28:29], v[28:29] op_sel:[0,0,1] op_sel_hi:[1,0,1]
    v_cvt_pk_bf16_f32 v90, v34, v35
    v_lshlrev_b32 v36, 16, v91
    v_and_b32 v37, 0xffff0000, v91
    v_pk_fma_f32 v[36:37], v[36:37], v[28:29], v[28:29] op_sel:[0,0,1] op_sel_hi:[1,0,1]
    v_cvt_pk_bf16_f32 v91, v36, v37
    v_lshlrev_b32 v30, 16, v92
    v_and_b32 v31, 0xffff0000, v92
    v_pk_fma_f32 v[30:31], v[30:31], v[28:29], v[28:29] op_sel:[0,0,1] op_sel_hi:[1,0,1]
    v_cvt_pk_bf16_f32 v92, v30, v31
    v_lshlrev_b32 v32, 16, v93
    v_and_b32 v33, 0xffff0000, v93
    v_pk_fma_f32 v[32:33], v[32:33], v[28:29], v[28:29] op_sel:[0,0,1] op_sel_hi:[1,0,1]
    v_cvt_pk_bf16_f32 v93, v32, v33
    v_lshlrev_b32 v34, 16, v94
    v_and_b32 v35, 0xffff0000, v94
    v_pk_fma_f32 v[34:35], v[34:35], v[28:29], v[28:29] op_sel:[0,0,1] op_sel_hi:[1,0,1]
    v_cvt_pk_bf16_f32 v94, v34, v35
    s_add_u32 m0, s58, 103424
    s_nop 0
    buffer_load_dwordx4 v42, s[8:11], s60 offen lds
    v_lshlrev_b32 v36, 16, v95
    v_and_b32 v37, 0xffff0000, v95
    v_pk_fma_f32 v[36:37], v[36:37], v[28:29], v[28:29] op_sel:[0,0,1] op_sel_hi:[1,0,1]
    v_cvt_pk_bf16_f32 v95, v36, v37
    v_lshlrev_b32 v30, 16, v96
    v_and_b32 v31, 0xffff0000, v96
    v_pk_fma_f32 v[30:31], v[30:31], v[28:29], v[28:29] op_sel:[0,0,1] op_sel_hi:[1,0,1]
    v_cvt_pk_bf16_f32 v96, v30, v31
    v_lshlrev_b32 v32, 16, v97
    v_and_b32 v33, 0xffff0000, v97
    v_pk_fma_f32 v[32:33], v[32:33], v[28:29], v[28:29] op_sel:[0,0,1] op_sel_hi:[1,0,1]
    v_cvt_pk_bf16_f32 v97, v32, v33
    v_lshlrev_b32 v34, 16, v98
    v_and_b32 v35, 0xffff0000, v98
    v_pk_fma_f32 v[34:35], v[34:35], v[28:29], v[28:29] op_sel:[0,0,1] op_sel_hi:[1,0,1]
    v_cvt_pk_bf16_f32 v98, v34, v35
    v_lshlrev_b32 v36, 16, v99
    v_and_b32 v37, 0xffff0000, v99
    v_pk_fma_f32 v[36:37], v[36:37], v[28:29], v[28:29] op_sel:[0,0,1] op_sel_hi:[1,0,1]
    v_cvt_pk_bf16_f32 v99, v36, v37
    v_lshlrev_b32 v30, 16, v100
    v_and_b32 v31, 0xffff0000, v100
    v_pk_fma_f32 v[30:31], v[30:31], v[28:29], v[28:29] op_sel:[0,0,1] op_sel_hi:[1,0,1]
    v_cvt_pk_bf16_f32 v100, v30, v31
    s_add_u32 m0, s58, 104448
    s_nop 0
    buffer_load_dwordx4 v43, s[8:11], s60 offen lds
    v_lshlrev_b32 v32, 16, v101
    v_and_b32 v33, 0xffff0000, v101
    v_pk_fma_f32 v[32:33], v[32:33], v[28:29], v[28:29] op_sel:[0,0,1] op_sel_hi:[1,0,1]
    v_cvt_pk_bf16_f32 v101, v32, v33
    v_lshlrev_b32 v34, 16, v102
    v_and_b32 v35, 0xffff0000, v102
    v_pk_fma_f32 v[34:35], v[34:35], v[28:29], v[28:29] op_sel:[0,0,1] op_sel_hi:[1,0,1]
    v_cvt_pk_bf16_f32 v102, v34, v35
    v_lshlrev_b32 v36, 16, v103
    v_and_b32 v37, 0xffff0000, v103
    v_pk_fma_f32 v[36:37], v[36:37], v[28:29], v[28:29] op_sel:[0,0,1] op_sel_hi:[1,0,1]
    v_cvt_pk_bf16_f32 v103, v36, v37
    v_lshlrev_b32 v30, 16, v104
    v_and_b32 v31, 0xffff0000, v104
    v_pk_fma_f32 v[30:31], v[30:31], v[28:29], v[28:29] op_sel:[0,0,1] op_sel_hi:[1,0,1]
    v_cvt_pk_bf16_f32 v104, v30, v31
    v_lshlrev_b32 v32, 16, v105
    v_and_b32 v33, 0xffff0000, v105
    v_pk_fma_f32 v[32:33], v[32:33], v[28:29], v[28:29] op_sel:[0,0,1] op_sel_hi:[1,0,1]
    v_cvt_pk_bf16_f32 v105, v32, v33
    v_lshlrev_b32 v34, 16, v106
    v_and_b32 v35, 0xffff0000, v106
    v_pk_fma_f32 v[34:35], v[34:35], v[28:29], v[28:29] op_sel:[0,0,1] op_sel_hi:[1,0,1]
    v_cvt_pk_bf16_f32 v106, v34, v35
    s_add_u32 m0, s58, 105472
    s_nop 0
    buffer_load_dwordx4 v44, s[8:11], s60 offen lds
    v_lshlrev_b32 v36, 16, v107
    v_and_b32 v37, 0xffff0000, v107
    v_pk_fma_f32 v[36:37], v[36:37], v[28:29], v[28:29] op_sel:[0,0,1] op_sel_hi:[1,0,1]
    v_cvt_pk_bf16_f32 v107, v36, v37
    v_lshlrev_b32 v30, 16, v108
    v_and_b32 v31, 0xffff0000, v108
    v_pk_fma_f32 v[30:31], v[30:31], v[28:29], v[28:29] op_sel:[0,0,1] op_sel_hi:[1,0,1]
    v_cvt_pk_bf16_f32 v108, v30, v31
    v_lshlrev_b32 v32, 16, v109
    v_and_b32 v33, 0xffff0000, v109
    v_pk_fma_f32 v[32:33], v[32:33], v[28:29], v[28:29] op_sel:[0,0,1] op_sel_hi:[1,0,1]
    v_cvt_pk_bf16_f32 v109, v32, v33
    v_lshlrev_b32 v34, 16, v110
    v_and_b32 v35, 0xffff0000, v110
    v_pk_fma_f32 v[34:35], v[34:35], v[28:29], v[28:29] op_sel:[0,0,1] op_sel_hi:[1,0,1]
    v_cvt_pk_bf16_f32 v110, v34, v35
    v_lshlrev_b32 v36, 16, v111
    v_and_b32 v37, 0xffff0000, v111
    v_pk_fma_f32 v[36:37], v[36:37], v[28:29], v[28:29] op_sel:[0,0,1] op_sel_hi:[1,0,1]
    v_cvt_pk_bf16_f32 v111, v36, v37
    v_lshlrev_b32 v30, 16, v112
    v_and_b32 v31, 0xffff0000, v112
    v_pk_fma_f32 v[30:31], v[30:31], v[28:29], v[28:29] op_sel:[0,0,1] op_sel_hi:[1,0,1]
    v_cvt_pk_bf16_f32 v112, v30, v31
    v_lshlrev_b32 v32, 16, v113
    v_and_b32 v33, 0xffff0000, v113
    v_pk_fma_f32 v[32:33], v[32:33], v[28:29], v[28:29] op_sel:[0,0,1] op_sel_hi:[1,0,1]
    v_cvt_pk_bf16_f32 v113, v32, v33
    s_add_u32 m0, s58, 106496
    s_nop 0
    buffer_load_dwordx4 v45, s[8:11], s60 offen lds
    v_lshlrev_b32 v34, 16, v114
    v_and_b32 v35, 0xffff0000, v114
    v_pk_fma_f32 v[34:35], v[34:35], v[28:29], v[28:29] op_sel:[0,0,1] op_sel_hi:[1,0,1]
    v_cvt_pk_bf16_f32 v114, v34, v35
    v_lshlrev_b32 v36, 16, v115
    v_and_b32 v37, 0xffff0000, v115
    v_pk_fma_f32 v[36:37], v[36:37], v[28:29], v[28:29] op_sel:[0,0,1] op_sel_hi:[1,0,1]
    v_cvt_pk_bf16_f32 v115, v36, v37
    v_lshlrev_b32 v30, 16, v116
    v_and_b32 v31, 0xffff0000, v116
    v_pk_fma_f32 v[30:31], v[30:31], v[28:29], v[28:29] op_sel:[0,0,1] op_sel_hi:[1,0,1]
    v_cvt_pk_bf16_f32 v116, v30, v31
    v_lshlrev_b32 v32, 16, v117
    v_and_b32 v33, 0xffff0000, v117
    v_pk_fma_f32 v[32:33], v[32:33], v[28:29], v[28:29] op_sel:[0,0,1] op_sel_hi:[1,0,1]
    v_cvt_pk_bf16_f32 v117, v32, v33
    v_lshlrev_b32 v34, 16, v118
    v_and_b32 v35, 0xffff0000, v118
    v_pk_fma_f32 v[34:35], v[34:35], v[28:29], v[28:29] op_sel:[0,0,1] op_sel_hi:[1,0,1]
    v_cvt_pk_bf16_f32 v118, v34, v35
    v_lshlrev_b32 v36, 16, v119
    v_and_b32 v37, 0xffff0000, v119
    v_pk_fma_f32 v[36:37], v[36:37], v[28:29], v[28:29] op_sel:[0,0,1] op_sel_hi:[1,0,1]
    v_cvt_pk_bf16_f32 v119, v36, v37
    v_lshlrev_b32 v30, 16, v120
    v_and_b32 v31, 0xffff0000, v120
    v_pk_fma_f32 v[30:31], v[30:31], v[28:29], v[28:29] op_sel:[0,0,1] op_sel_hi:[1,0,1]
    v_cvt_pk_bf16_f32 v120, v30, v31
    v_lshlrev_b32 v32, 16, v121
    v_and_b32 v33, 0xffff0000, v121
    v_pk_fma_f32 v[32:33], v[32:33], v[28:29], v[28:29] op_sel:[0,0,1] op_sel_hi:[1,0,1]
    v_cvt_pk_bf16_f32 v121, v32, v33
    v_lshlrev_b32 v34, 16, v122
    v_and_b32 v35, 0xffff0000, v122
    v_pk_fma_f32 v[34:35], v[34:35], v[28:29], v[28:29] op_sel:[0,0,1] op_sel_hi:[1,0,1]
    v_cvt_pk_bf16_f32 v122, v34, v35
    v_lshlrev_b32 v36, 16, v123
    v_and_b32 v37, 0xffff0000, v123
    v_pk_fma_f32 v[36:37], v[36:37], v[28:29], v[28:29] op_sel:[0,0,1] op_sel_hi:[1,0,1]
    v_cvt_pk_bf16_f32 v123, v36, v37
    v_lshlrev_b32 v30, 16, v124
    v_and_b32 v31, 0xffff0000, v124
    v_pk_fma_f32 v[30:31], v[30:31], v[28:29], v[28:29] op_sel:[0,0,1] op_sel_hi:[1,0,1]
    v_cvt_pk_bf16_f32 v124, v30, v31
    v_lshlrev_b32 v32, 16, v125
    v_and_b32 v33, 0xffff0000, v125
    v_pk_fma_f32 v[32:33], v[32:33], v[28:29], v[28:29] op_sel:[0,0,1] op_sel_hi:[1,0,1]
    v_cvt_pk_bf16_f32 v125, v32, v33
    v_lshlrev_b32 v34, 16, v126
    v_and_b32 v35, 0xffff0000, v126
    v_pk_fma_f32 v[34:35], v[34:35], v[28:29], v[28:29] op_sel:[0,0,1] op_sel_hi:[1,0,1]
    v_cvt_pk_bf16_f32 v126, v34, v35
    v_lshlrev_b32 v36, 16, v127
    v_and_b32 v37, 0xffff0000, v127
    v_pk_fma_f32 v[36:37], v[36:37], v[28:29], v[28:29] op_sel:[0,0,1] op_sel_hi:[1,0,1]
    v_cvt_pk_bf16_f32 v127, v36, v37
    v_lshlrev_b32 v30, 16, v128
    v_and_b32 v31, 0xffff0000, v128
    v_pk_fma_f32 v[30:31], v[30:31], v[28:29], v[28:29] op_sel:[0,0,1] op_sel_hi:[1,0,1]
    v_cvt_pk_bf16_f32 v128, v30, v31
    v_lshlrev_b32 v32, 16, v129
    v_and_b32 v33, 0xffff0000, v129
    v_pk_fma_f32 v[32:33], v[32:33], v[28:29], v[28:29] op_sel:[0,0,1] op_sel_hi:[1,0,1]
    v_cvt_pk_bf16_f32 v129, v32, v33
    v_lshlrev_b32 v34, 16, v130
    v_and_b32 v35, 0xffff0000, v130
    v_pk_fma_f32 v[34:35], v[34:35], v[28:29], v[28:29] op_sel:[0,0,1] op_sel_hi:[1,0,1]
    v_cvt_pk_bf16_f32 v130, v34, v35
    v_lshlrev_b32 v36, 16, v131
    v_and_b32 v37, 0xffff0000, v131
    v_pk_fma_f32 v[36:37], v[36:37], v[28:29], v[28:29] op_sel:[0,0,1] op_sel_hi:[1,0,1]
    v_cvt_pk_bf16_f32 v131, v36, v37
    s_waitcnt vmcnt(16)
    s_waitcnt vmcnt(6)
    s_barrier
    s_add_u32 s60, s64, 984320
    s_add_u32 m0, s58, 0
    s_nop 0
    buffer_load_dwordx4 v41, s[8:11], s60 offen lds
    s_add_u32 m0, s58, 1024
    s_nop 0
    buffer_load_dwordx4 v42, s[8:11], s60 offen lds
    s_add_u32 m0, s58, 2048
    s_nop 0
    buffer_load_dwordx4 v43, s[8:11], s60 offen lds
    s_add_u32 m0, s58, 3072
    s_nop 0
    buffer_load_dwordx4 v44, s[8:11], s60 offen lds
    s_add_u32 m0, s58, 4096
    s_nop 0
    buffer_load_dwordx4 v45, s[8:11], s60 offen lds
    v_lshlrev_b32 v13, 3, v0
    v_mov_b32 v38, 0
    v_mov_b32 v39, 0
    v_add_u32 v13, 75776, v13
    ds_write_b64 v13, v[38:39]
    v_lshlrev_b32 v13, 4, v0
    v_min_u32 v13, 3200, v13
    v_add_u32 v13, 77824, v13
    ds_write_b128 v13, v[18:21]
    s_cmp_lg_u32 s3, 3
    s_cbranch_scc1 L_w_6
    s_getreg_b32 s56, hwreg(HW_REG_XCC_ID, 0, 3)
    s_or_b32 s56, s56, s71
    v_mov_b32 v18, s70
    v_mov_b32 v19, s56
    s_lshl_b32 s56, s53, 3
    s_add_u32 s56, s56, s52
    s_lshl_b32 s56, s56, 3
    s_add_u32 s56, s56, 0xc44000
    s_mov_b64 exec, 1
    buffer_store_dwordx2 v[18:19], v6, s[12:15], s56 offen sc1
    s_mov_b64 exec, -1
L_w_6:
    ds_read_b64_tr_b16 v[22:23], v47 offset:16384
    ds_read_b64_tr_b16 v[24:25], v47 offset:17664
    ds_read_b64_tr_b16 v[26:27], v47 offset:16392
    ds_read_b64_tr_b16 v[28:29], v47 offset:17672
    ds_read_b64_tr_b16 v[30:31], v47 offset:16400
    ds_read_b64_tr_b16 v[32:33], v47 offset:17680
    ds_read_b64_tr_b16 v[34:35], v47 offset:16408
    ds_read_b64_tr_b16 v[36:37], v47 offset:17688
    ds_read_b64_tr_b16 v[142:143], v47 offset:16416
    ds_read_b64_tr_b16 v[144:145], v47 offset:17696
    ds_read_b64_tr_b16 v[146:147], v47 offset:21504
    ds_read_b64_tr_b16 v[148:149], v47 offset:22784
    ds_read_b64_tr_b16 v[150:151], v47 offset:21512
    ds_read_b64_tr_b16 v[152:153], v47 offset:22792
    ds_read_b64_tr_b16 v[154:155], v47 offset:21520
    ds_read_b64_tr_b16 v[156:157], v47 offset:22800
    ds_read_b64_tr_b16 v[158:159], v47 offset:21528
    ds_read_b64_tr_b16 v[160:161], v47 offset:22808
    ds_read_b64_tr_b16 v[162:163], v47 offset:21536
    ds_read_b64_tr_b16 v[164:165], v47 offset:22816
    s_waitcnt lgkmcnt(10)
    v_mfma_f32_16x16x32_bf16 v[186:189], v[22:25], v[52:55], 0
    ds_read_b64_tr_b16 v[166:167], v47 offset:26624
    ds_read_b64_tr_b16 v[168:169], v47 offset:27904
    v_mfma_f32_16x16x32_bf16 v[190:193], v[26:29], v[52:55], 0
    ds_read_b64_tr_b16 v[170:171], v47 offset:26632
    ds_read_b64_tr_b16 v[172:173], v47 offset:27912
    v_mfma_f32_16x16x32_bf16 v[194:197], v[30:33], v[52:55], 0
    ds_read_b64_tr_b16 v[174:175], v47 offset:26640
    ds_read_b64_tr_b16 v[176:177], v47 offset:27920
    v_mfma_f32_16x16x32_bf16 v[198:201], v[34:37], v[52:55], 0
    ds_read_b64_tr_b16 v[178:179], v47 offset:26648
    ds_read_b64_tr_b16 v[180:181], v47 offset:27928
    v_mfma_f32_16x16x32_bf16 v[202:205], v[142:145], v[52:55], 0
    ds_read_b64_tr_b16 v[182:183], v47 offset:26656
    ds_read_b64_tr_b16 v[184:185], v47 offset:27936
    s_waitcnt lgkmcnt(10)
    v_mfma_f32_16x16x32_bf16 v[186:189], v[146:149], v[56:59], v[186:189]
    ds_read_b64_tr_b16 v[22:23], v47 offset:31744
    ds_read_b64_tr_b16 v[24:25], v47 offset:33024
    v_mfma_f32_16x16x32_bf16 v[190:193], v[150:153], v[56:59], v[190:193]
    ds_read_b64_tr_b16 v[26:27], v47 offset:31752
    ds_read_b64_tr_b16 v[28:29], v47 offset:33032
    v_mfma_f32_16x16x32_bf16 v[194:197], v[154:157], v[56:59], v[194:197]
    ds_read_b64_tr_b16 v[30:31], v47 offset:31760
    ds_read_b64_tr_b16 v[32:33], v47 offset:33040
    v_mfma_f32_16x16x32_bf16 v[198:201], v[158:161], v[56:59], v[198:201]
    ds_read_b64_tr_b16 v[34:35], v47 offset:31768
    ds_read_b64_tr_b16 v[36:37], v47 offset:33048
    v_mfma_f32_16x16x32_bf16 v[202:205], v[162:165], v[56:59], v[202:205]
    ds_read_b64_tr_b16 v[142:143], v47 offset:31776
    ds_read_b64_tr_b16 v[144:145], v47 offset:33056
    s_waitcnt vmcnt(5)
    s_barrier
    s_add_u32 s60, s64, 1475840
    s_add_u32 m0, s58, 20480
    s_nop 0
    buffer_load_dwordx4 v41, s[8:11], s60 offen lds
    s_add_u32 m0, s58, 21504
    s_nop 0
    buffer_load_dwordx4 v42, s[8:11], s60 offen lds
    s_add_u32 m0, s58, 22528
    s_nop 0
    buffer_load_dwordx4 v43, s[8:11], s60 offen lds
    s_add_u32 m0, s58, 23552
    s_nop 0
    buffer_load_dwordx4 v44, s[8:11], s60 offen lds
    s_add_u32 m0, s58, 24576
    s_nop 0
    buffer_load_dwordx4 v45, s[8:11], s60 offen lds
    v_mul_u32_u24 v14, 800, v2
    v_mad_u32_u24 v14, v4, 40, v14
    v_add_u32 v14, 77824, v14
    v_cmp_eq_u32 vcc, v2, v5
    v_mov_b32 v13, 75776
    s_nop 0
    v_cndmask_b32 v13, v13, v14, vcc
    ds_read_b64_tr_b16 a[196:197], v13 offset:0
    ds_read_b64_tr_b16 a[198:199], v13 offset:160
    ds_read_b64_tr_b16 a[200:201], v13 offset:8
    ds_read_b64_tr_b16 a[202:203], v13 offset:168
    ds_read_b64_tr_b16 a[204:205], v13 offset:16
    ds_read_b64_tr_b16 a[206:207], v13 offset:176
    ds_read_b64_tr_b16 a[208:209], v13 offset:24
    ds_read_b64_tr_b16 a[210:211], v13 offset:184
    ds_read_b64_tr_b16 a[212:213], v13 offset:32
    ds_read_b64_tr_b16 a[214:215], v13 offset:192
    ds_read_b64_tr_b16 a[216:217], v13 offset:320
    ds_read_b64_tr_b16 a[218:219], v13 offset:480
    ds_read_b64_tr_b16 a[220:221], v13 offset:328
    ds_read_b64_tr_b16 a[222:223], v13 offset:488
    ds_read_b64_tr_b16 a[224:225], v13 offset:336
    ds_read_b64_tr_b16 a[226:227], v13 offset:496
    ds_read_b64_tr_b16 a[228:229], v13 offset:344
    ds_read_b64_tr_b16 a[230:231], v13 offset:504
    ds_read_b64_tr_b16 a[232:233], v13 offset:352
    ds_read_b64_tr_b16 a[234:235], v13 offset:512
    ds_read_b64_tr_b16 a[236:237], v13 offset:640
    v_accvgpr_write_b32 a238, 0
    v_accvgpr_write_b32 a239, 0
    ds_read_b64_tr_b16 a[240:241], v13 offset:648
    v_accvgpr_write_b32 a242, 0
    v_accvgpr_write_b32 a243, 0
    ds_read_b64_tr_b16 a[244:245], v13 offset:656
    v_accvgpr_write_b32 a246, 0
    v_accvgpr_write_b32 a247, 0
    ds_read_b64_tr_b16 a[248:249], v13 offset:664
    v_accvgpr_write_b32 a250, 0
    v_accvgpr_write_b32 a251, 0
    ds_read_b64_tr_b16 a[252:253], v13 offset:672
    v_accvgpr_write_b32 a254, 0
    v_accvgpr_write_b32 a255, 0
    s_waitcnt lgkmcnt(0)
    v_mfma_f32_16x16x32_bf16 v[186:189], v[166:169], v[60:63], v[186:189]
    ds_read_b64_tr_b16 v[146:147], v47 offset:36864
    ds_read_b64_tr_b16 v[148:149], v47 offset:38144
    v_mfma_f32_16x16x32_bf16 v[190:193], v[170:173], v[60:63], v[190:193]
    ds_read_b64_tr_b16 v[150:151], v47 offset:36872
    ds_read_b64_tr_b16 v[152:153], v47 offset:38152
    v_mfma_f32_16x16x32_bf16 v[194:197], v[174:177], v[60:63], v[194:197]
    ds_read_b64_tr_b16 v[154:155], v47 offset:36880
    ds_read_b64_tr_b16 v[156:157], v47 offset:38160
    v_mfma_f32_16x16x32_bf16 v[198:201], v[178:181], v[60:63], v[198:201]
    ds_read_b64_tr_b16 v[158:159], v47 offset:36888
    ds_read_b64_tr_b16 v[160:161], v47 offset:38168
    v_mfma_f32_16x16x32_bf16 v[202:205], v[182:185], v[60:63], v[202:205]
    ds_read_b64_tr_b16 v[162:163], v47 offset:36896
    ds_read_b64_tr_b16 v[164:165], v47 offset:38176
    v_mfma_f32_16x16x32_bf16 v[186:189], v[22:25], v[64:67], v[186:189]
    ds_read_b64_tr_b16 v[166:167], v47 offset:41984
    ds_read_b64_tr_b16 v[168:169], v47 offset:43264
    v_mfma_f32_16x16x32_bf16 v[190:193], v[26:29], v[64:67], v[190:193]
    ds_read_b64_tr_b16 v[170:171], v47 offset:41992
    ds_read_b64_tr_b16 v[172:173], v47 offset:43272
    v_mfma_f32_16x16x32_bf16 v[194:197], v[30:33], v[64:67], v[194:197]
    ds_read_b64_tr_b16 v[174:175], v47 offset:42000
    ds_read_b64_tr_b16 v[176:177], v47 offset:43280
    v_mfma_f32_16x16x32_bf16 v[198:201], v[34:37], v[64:67], v[198:201]
    ds_read_b64_tr_b16 v[178:179], v47 offset:42008
    ds_read_b64_tr_b16 v[180:181], v47 offset:43288
    v_mfma_f32_16x16x32_bf16 v[202:205], v[142:145], v[64:67], v[202:205]
    ds_read_b64_tr_b16 v[182:183], v47 offset:42016
    ds_read_b64_tr_b16 v[184:185], v47 offset:43296
    s_waitcnt lgkmcnt(10)
    v_mfma_f32_16x16x32_bf16 v[186:189], v[146:149], v[68:71], v[186:189]
    ds_read_b64_tr_b16 v[22:23], v47 offset:47104
    ds_read_b64_tr_b16 v[24:25], v47 offset:48384
    v_mfma_f32_16x16x32_bf16 v[190:193], v[150:153], v[68:71], v[190:193]
    ds_read_b64_tr_b16 v[26:27], v47 offset:47112
    ds_read_b64_tr_b16 v[28:29], v47 offset:48392
    v_mfma_f32_16x16x32_bf16 v[194:197], v[154:157], v[68:71], v[194:197]
    ds_read_b64_tr_b16 v[30:31], v47 offset:47120
    ds_read_b64_tr_b16 v[32:33], v47 offset:48400
    v_mfma_f32_16x16x32_bf16 v[198:201], v[158:161], v[68:71], v[198:201]
    ds_read_b64_tr_b16 v[34:35], v47 offset:47128
    ds_read_b64_tr_b16 v[36:37], v47 offset:48408
    v_mfma_f32_16x16x32_bf16 v[202:205], v[162:165], v[68:71], v[202:205]
    ds_read_b64_tr_b16 v[142:143], v47 offset:47136
    ds_read_b64_tr_b16 v[144:145], v47 offset:48416
    s_waitcnt lgkmcnt(10)
    v_mfma_f32_16x16x32_bf16 v[186:189], v[166:169], v[72:75], v[186:189]
    ds_read_b64_tr_b16 v[146:147], v47 offset:52224
    ds_read_b64_tr_b16 v[148:149], v47 offset:53504
    v_mfma_f32_16x16x32_bf16 v[190:193], v[170:173], v[72:75], v[190:193]
    ds_read_b64_tr_b16 v[150:151], v47 offset:52232
    ds_read_b64_tr_b16 v[152:153], v47 offset:53512
    v_mfma_f32_16x16x32_bf16 v[194:197], v[174:177], v[72:75], v[194:197]
    ds_read_b64_tr_b16 v[154:155], v47 offset:52240
    ds_read_b64_tr_b16 v[156:157], v47 offset:53520
    v_mfma_f32_16x16x32_bf16 v[198:201], v[178:181], v[72:75], v[198:201]
    ds_read_b64_tr_b16 v[158:159], v47 offset:52248
    ds_read_b64_tr_b16 v[160:161], v47 offset:53528
    v_mfma_f32_16x16x32_bf16 v[202:205], v[182:185], v[72:75], v[202:205]
    ds_read_b64_tr_b16 v[162:163], v47 offset:52256
    ds_read_b64_tr_b16 v[164:165], v47 offset:53536
    s_waitcnt vmcnt(5)
    s_barrier
    s_add_u32 s60, s64, 1967360
    s_add_u32 m0, s58, 122880
    s_nop 0
    buffer_load_dwordx4 v41, s[8:11], s60 offen lds
    s_add_u32 m0, s58, 123904
    s_nop 0
    buffer_load_dwordx4 v42, s[8:11], s60 offen lds
    s_add_u32 m0, s58, 124928
    s_nop 0
    buffer_load_dwordx4 v43, s[8:11], s60 offen lds
    s_add_u32 m0, s58, 125952
    s_nop 0
    buffer_load_dwordx4 v44, s[8:11], s60 offen lds
    s_add_u32 m0, s58, 126976
    s_nop 0
    buffer_load_dwordx4 v45, s[8:11], s60 offen lds
    s_waitcnt lgkmcnt(10)
    v_mfma_f32_16x16x32_bf16 v[186:189], v[22:25], v[76:79], v[186:189]
    ds_read_b64_tr_b16 v[166:167], v46 offset:0
    ds_read_b64_tr_b16 v[168:169], v46 offset:1280
    v_mfma_f32_16x16x32_bf16 v[190:193], v[26:29], v[76:79], v[190:193]
    ds_read_b64_tr_b16 v[170:171], v46 offset:8
    ds_read_b64_tr_b16 v[172:173], v46 offset:1288
    v_mfma_f32_16x16x32_bf16 v[194:197], v[30:33], v[76:79], v[194:197]
    ds_read_b64_tr_b16 v[174:175], v46 offset:16
    ds_read_b64_tr_b16 v[176:177], v46 offset:1296
    v_mfma_f32_16x16x32_bf16 v[198:201], v[34:37], v[76:79], v[198:201]
    ds_read_b64_tr_b16 v[178:179], v46 offset:24
    ds_read_b64_tr_b16 v[180:181], v46 offset:1304
    v_mfma_f32_16x16x32_bf16 v[202:205], v[142:145], v[76:79], v[202:205]
    ds_read_b64_tr_b16 v[182:183], v46 offset:32
    ds_read_b64_tr_b16 v[184:185], v46 offset:1312
    s_waitcnt lgkmcnt(10)
    v_mfma_f32_16x16x32_bf16 v[186:189], v[146:149], v[80:83], v[186:189]
    ds_read_b64_tr_b16 v[22:23], v46 offset:5120
    ds_read_b64_tr_b16 v[24:25], v46 offset:6400
    v_mfma_f32_16x16x32_bf16 v[190:193], v[150:153], v[80:83], v[190:193]
    ds_read_b64_tr_b16 v[26:27], v46 offset:5128
    ds_read_b64_tr_b16 v[28:29], v46 offset:6408
    v_mfma_f32_16x16x32_bf16 v[194:197], v[154:157], v[80:83], v[194:197]
    ds_read_b64_tr_b16 v[30:31], v46 offset:5136
    ds_read_b64_tr_b16 v[32:33], v46 offset:6416
    v_mfma_f32_16x16x32_bf16 v[198:201], v[158:161], v[80:83], v[198:201]
    ds_read_b64_tr_b16 v[34:35], v46 offset:5144
    ds_read_b64_tr_b16 v[36:37], v46 offset:6424
    v_mfma_f32_16x16x32_bf16 v[202:205], v[162:165], v[80:83], v[202:205]
    ds_read_b64_tr_b16 v[142:143], v46 offset:5152
    ds_read_b64_tr_b16 v[144:145], v46 offset:6432
    s_waitcnt lgkmcnt(10)
    v_mfma_f32_16x16x32_bf16 v[186:189], v[166:169], v[84:87], v[186:189]
    ds_read_b64_tr_b16 v[146:147], v46 offset:10240
    ds_read_b64_tr_b16 v[148:149], v46 offset:11520
    v_mfma_f32_16x16x32_bf16 v[190:193], v[170:173], v[84:87], v[190:193]
    ds_read_b64_tr_b16 v[150:151], v46 offset:10248
    ds_read_b64_tr_b16 v[152:153], v46 offset:11528
    v_mfma_f32_16x16x32_bf16 v[194:197], v[174:177], v[84:87], v[194:197]
    ds_read_b64_tr_b16 v[154:155], v46 offset:10256
    ds_read_b64_tr_b16 v[156:157], v46 offset:11536
    v_mfma_f32_16x16x32_bf16 v[198:201], v[178:181], v[84:87], v[198:201]
    ds_read_b64_tr_b16 v[158:159], v46 offset:10264
    ds_read_b64_tr_b16 v[160:161], v46 offset:11544
    v_mfma_f32_16x16x32_bf16 v[202:205], v[182:185], v[84:87], v[202:205]
    ds_read_b64_tr_b16 v[162:163], v46 offset:10272
    ds_read_b64_tr_b16 v[164:165], v46 offset:11552
    s_waitcnt lgkmcnt(10)
    v_mfma_f32_16x16x32_bf16 v[186:189], v[22:25], v[88:91], v[186:189]
    ds_read_b64_tr_b16 v[166:167], v46 offset:15360
    ds_read_b64_tr_b16 v[168:169], v46 offset:16640
    v_mfma_f32_16x16x32_bf16 v[190:193], v[26:29], v[88:91], v[190:193]
    ds_read_b64_tr_b16 v[170:171], v46 offset:15368
    ds_read_b64_tr_b16 v[172:173], v46 offset:16648
    v_mfma_f32_16x16x32_bf16 v[194:197], v[30:33], v[88:91], v[194:197]
    ds_read_b64_tr_b16 v[174:175], v46 offset:15376
    ds_read_b64_tr_b16 v[176:177], v46 offset:16656
    v_mfma_f32_16x16x32_bf16 v[198:201], v[34:37], v[88:91], v[198:201]
    ds_read_b64_tr_b16 v[178:179], v46 offset:15384
    ds_read_b64_tr_b16 v[180:181], v46 offset:16664
    v_mfma_f32_16x16x32_bf16 v[202:205], v[142:145], v[88:91], v[202:205]
    ds_read_b64_tr_b16 v[182:183], v46 offset:15392
    ds_read_b64_tr_b16 v[184:185], v46 offset:16672
    s_waitcnt vmcnt(5)
    s_barrier
    s_mov_b32 s56, 0xc44000
    buffer_load_dwordx4 v[206:209], v8, s[12:15], s56 offen sc1
    buffer_load_dwordx4 v[210:213], v8, s[12:15], s56 offen offset:1024 sc1
    s_waitcnt lgkmcnt(10)
    v_mfma_f32_16x16x32_bf16 v[186:189], v[146:149], v[92:95], v[186:189]
    ds_read_b64_tr_b16 v[22:23], v46 offset:20480
    ds_read_b64_tr_b16 v[24:25], v46 offset:21760
    v_mfma_f32_16x16x32_bf16 v[190:193], v[150:153], v[92:95], v[190:193]
    ds_read_b64_tr_b16 v[26:27], v46 offset:20488
    ds_read_b64_tr_b16 v[28:29], v46 offset:21768
    v_mfma_f32_16x16x32_bf16 v[194:197], v[154:157], v[92:95], v[194:197]
    ds_read_b64_tr_b16 v[30:31], v46 offset:20496
    ds_read_b64_tr_b16 v[32:33], v46 offset:21776
    v_mfma_f32_16x16x32_bf16 v[198:201], v[158:161], v[92:95], v[198:201]
    ds_read_b64_tr_b16 v[34:35], v46 offset:20504
    ds_read_b64_tr_b16 v[36:37], v46 offset:21784
    v_mfma_f32_16x16x32_bf16 v[202:205], v[162:165], v[92:95], v[202:205]
    ds_read_b64_tr_b16 v[142:143], v46 offset:20512
    ds_read_b64_tr_b16 v[144:145], v46 offset:21792
    s_waitcnt lgkmcnt(10)
    v_mfma_f32_16x16x32_bf16 v[186:189], v[166:169], v[96:99], v[186:189]
    ds_read_b64_tr_b16 v[146:147], v46 offset:25600
    ds_read_b64_tr_b16 v[148:149], v46 offset:26880
    v_mfma_f32_16x16x32_bf16 v[190:193], v[170:173], v[96:99], v[190:193]
    ds_read_b64_tr_b16 v[150:151], v46 offset:25608
    ds_read_b64_tr_b16 v[152:153], v46 offset:26888
    v_mfma_f32_16x16x32_bf16 v[194:197], v[174:177], v[96:99], v[194:197]
    ds_read_b64_tr_b16 v[154:155], v46 offset:25616
    ds_read_b64_tr_b16 v[156:157], v46 offset:26896
    v_mfma_f32_16x16x32_bf16 v[198:201], v[178:181], v[96:99], v[198:201]
    ds_read_b64_tr_b16 v[158:159], v46 offset:25624
    ds_read_b64_tr_b16 v[160:161], v46 offset:26904
    v_mfma_f32_16x16x32_bf16 v[202:205], v[182:185], v[96:99], v[202:205]
    ds_read_b64_tr_b16 v[162:163], v46 offset:25632
    ds_read_b64_tr_b16 v[164:165], v46 offset:26912
    s_waitcnt lgkmcnt(10)
    v_mfma_f32_16x16x32_bf16 v[186:189], v[22:25], v[100:103], v[186:189]
    ds_read_b64_tr_b16 v[166:167], v46 offset:30720
    ds_read_b64_tr_b16 v[168:169], v46 offset:32000
    v_mfma_f32_16x16x32_bf16 v[190:193], v[26:29], v[100:103], v[190:193]
    ds_read_b64_tr_b16 v[170:171], v46 offset:30728
    ds_read_b64_tr_b16 v[172:173], v46 offset:32008
    v_mfma_f32_16x16x32_bf16 v[194:197], v[30:33], v[100:103], v[194:197]
    ds_read_b64_tr_b16 v[174:175], v46 offset:30736
    ds_read_b64_tr_b16 v[176:177], v46 offset:32016
    v_mfma_f32_16x16x32_bf16 v[198:201], v[34:37], v[100:103], v[198:201]
    ds_read_b64_tr_b16 v[178:179], v46 offset:30744
    ds_read_b64_tr_b16 v[180:181], v46 offset:32024
    v_mfma_f32_16x16x32_bf16 v[202:205], v[142:145], v[100:103], v[202:205]
    ds_read_b64_tr_b16 v[182:183], v46 offset:30752
    ds_read_b64_tr_b16 v[184:185], v46 offset:32032
    s_waitcnt lgkmcnt(10)
    v_mfma_f32_16x16x32_bf16 v[186:189], v[146:149], v[104:107], v[186:189]
    ds_read_b64_tr_b16 v[22:23], v46 offset:35840
    ds_read_b64_tr_b16 v[24:25], v46 offset:37120
    v_mfma_f32_16x16x32_bf16 v[190:193], v[150:153], v[104:107], v[190:193]
    ds_read_b64_tr_b16 v[26:27], v46 offset:35848
    ds_read_b64_tr_b16 v[28:29], v46 offset:37128
    v_mfma_f32_16x16x32_bf16 v[194:197], v[154:157], v[104:107], v[194:197]
    ds_read_b64_tr_b16 v[30:31], v46 offset:35856
    ds_read_b64_tr_b16 v[32:33], v46 offset:37136
    v_mfma_f32_16x16x32_bf16 v[198:201], v[158:161], v[104:107], v[198:201]
    ds_read_b64_tr_b16 v[34:35], v46 offset:35864
    ds_read_b64_tr_b16 v[36:37], v46 offset:37144
    v_mfma_f32_16x16x32_bf16 v[202:205], v[162:165], v[104:107], v[202:205]
    ds_read_b64_tr_b16 v[142:143], v46 offset:35872
    ds_read_b64_tr_b16 v[144:145], v46 offset:37152
    s_waitcnt vmcnt(2)
    s_barrier
    s_waitcnt vmcnt(0)
    s_mov_b32 s55, 0
L_chk_7:
    v_xor_b32 v14, s71, v207
    v_lshrrev_b32 v14, 3, v14
    v_xor_b32 v13, s70, v206
    v_or_b32 v13, v13, v14
    v_xor_b32 v14, s71, v209
    v_lshrrev_b32 v14, 3, v14
    v_or_b32 v14, v14, v13
    v_xor_b32 v13, s70, v208
    v_or_b32 v13, v13, v14
    v_xor_b32 v14, s71, v211
    v_lshrrev_b32 v14, 3, v14
    v_or_b32 v14, v14, v13
    v_xor_b32 v13, s70, v210
    v_or_b32 v13, v13, v14
    v_xor_b32 v14, s71, v213
    v_lshrrev_b32 v14, 3, v14
    v_or_b32 v14, v14, v13
    v_xor_b32 v13, s70, v212
    v_or_b32 v13, v13, v14
    v_cmp_ne_u32 vcc, 0, v13
    s_cbranch_vccz L_ok_8
    s_add_u32 s55, s55, 1
    s_cmp_gt_u32 s55, 262144
    s_cbranch_scc1 L_ok_8
    s_sleep 8
    s_mov_b32 s56, 0xc44000
    buffer_load_dwordx4 v[206:209], v8, s[12:15], s56 offen sc1
    buffer_load_dwordx4 v[210:213], v8, s[12:15], s56 offen offset:1024 sc1
    s_waitcnt vmcnt(0)
    s_branch L_chk_7
L_ok_8:
    s_getreg_b32 s56, hwreg(HW_REG_XCC_ID, 0, 3)
    s_or_b32 s56, s56, s71
    v_xor_b32 v13, s56, v207
    v_xor_b32 v14, s56, v209
    v_or_b32 v206, v13, v14
    v_xor_b32 v13, s56, v211
    v_xor_b32 v14, s56, v213
    v_or_b32 v210, v13, v14
    s_cmp_ge_u32 s53, 16
    s_cselect_b64 vcc, -1, 0
    v_cndmask_b32 v13, v206, v210, vcc
    v_cmp_ne_u32 vcc, 0, v13
    s_and_b32 s56, s53, 15
    s_lshl_b32 s56, s56, 2
    s_lshr_b64 vcc, vcc, s56
    s_and_b32 s57, vcc_lo, 15
    s_cmp_eq_u32 s57, 0
    s_cselect_b32 s54, 1, 0
    s_add_u32 s60, s75, 0
    s_add_u32 m0, s58, 143360
    s_nop 0
    buffer_load_dwordx4 v8, s[12:15], s60 offen offset:0 sc1 lds
    buffer_load_dwordx4 v8, s[12:15], s60 offen offset:1024 sc1 lds
    buffer_load_dwordx4 v8, s[12:15], s60 offen offset:2048 sc1 lds
    buffer_load_dwordx4 v8, s[12:15], s60 offen offset:3072 sc1 lds
    s_add_u32 s60, s60, 4096
    s_add_u32 m0, s58, 147456
    s_nop 0
    buffer_load_dwordx4 v8, s[12:15], s60 offen offset:0 sc1 lds
    s_add_u32 s60, s75, 20480
    s_add_u32 m0, s58, 81920
    s_nop 0
    buffer_load_dwordx4 v8, s[12:15], s60 offen offset:0 sc1 lds
    buffer_load_dwordx4 v8, s[12:15], s60 offen offset:1024 sc1 lds
    buffer_load_dwordx4 v8, s[12:15], s60 offen offset:2048 sc1 lds
    buffer_load_dwordx4 v8, s[12:15], s60 offen offset:3072 sc1 lds
    s_add_u32 s60, s60, 4096
    s_add_u32 m0, s58, 86016
    s_nop 0
    buffer_load_dwordx4 v8, s[12:15], s60 offen offset:0 sc1 lds
    s_waitcnt lgkmcnt(10)
    v_mfma_f32_16x16x32_bf16 v[186:189], v[166:169], v[108:111], v[186:189]
    ds_read_b64_tr_b16 v[146:147], v47 offset:57344
    ds_read_b64_tr_b16 v[148:149], v47 offset:58624
    v_mfma_f32_16x16x32_bf16 v[190:193], v[170:173], v[108:111], v[190:193]
    ds_read_b64_tr_b16 v[150:151], v47 offset:57352
    ds_read_b64_tr_b16 v[152:153], v47 offset:58632
    v_mfma_f32_16x16x32_bf16 v[194:197], v[174:177], v[108:111], v[194:197]
    ds_read_b64_tr_b16 v[154:155], v47 offset:57360
    ds_read_b64_tr_b16 v[156:157], v47 offset:58640
    v_mfma_f32_16x16x32_bf16 v[198:201], v[178:181], v[108:111], v[198:201]
    ds_read_b64_tr_b16 v[158:159], v47 offset:57368
    ds_read_b64_tr_b16 v[160:161], v47 offset:58648
    v_mfma_f32_16x16x32_bf16 v[202:205], v[182:185], v[108:111], v[202:205]
    ds_read_b64_tr_b16 v[162:163], v47 offset:57376
    ds_read_b64_tr_b16 v[164:165], v47 offset:58656
    s_waitcnt lgkmcnt(10)
    v_mfma_f32_16x16x32_bf16 v[186:189], v[22:25], v[112:115], v[186:189]
    ds_read_b64_tr_b16 v[166:167], v47 offset:62464
    ds_read_b64_tr_b16 v[168:169], v47 offset:63744
    v_mfma_f32_16x16x32_bf16 v[190:193], v[26:29], v[112:115], v[190:193]
    ds_read_b64_tr_b16 v[170:171], v47 offset:62472
    ds_read_b64_tr_b16 v[172:173], v47 offset:63752
    v_mfma_f32_16x16x32_bf16 v[194:197], v[30:33], v[112:115], v[194:197]
    ds_read_b64_tr_b16 v[174:175], v47 offset:62480
    ds_read_b64_tr_b16 v[176:177], v47 offset:63760
    v_mfma_f32_16x16x32_bf16 v[198:201], v[34:37], v[112:115], v[198:201]
    ds_read_b64_tr_b16 v[178:179], v47 offset:62488
    ds_read_b64_tr_b16 v[180:181], v47 offset:63768
    v_mfma_f32_16x16x32_bf16 v[202:205], v[142:145], v[112:115], v[202:205]
    ds_read_b64_tr_b16 v[182:183], v47 offset:62496
    ds_read_b64_tr_b16 v[184:185], v47 offset:63776
    s_waitcnt lgkmcnt(10)
    v_mfma_f32_16x16x32_bf16 v[186:189], v[146:149], v[116:119], v[186:189]
    ds_read_b64_tr_b16 v[22:23], v48 offset:2048
    ds_read_b64_tr_b16 v[24:25], v48 offset:3328
    v_mfma_f32_16x16x32_bf16 v[190:193], v[150:153], v[116:119], v[190:193]
    ds_read_b64_tr_b16 v[26:27], v48 offset:2056
    ds_read_b64_tr_b16 v[28:29], v48 offset:3336
    v_mfma_f32_16x16x32_bf16 v[194:197], v[154:157], v[116:119], v[194:197]
    ds_read_b64_tr_b16 v[30:31], v48 offset:2064
    ds_read_b64_tr_b16 v[32:33], v48 offset:3344
    v_mfma_f32_16x16x32_bf16 v[198:201], v[158:161], v[116:119], v[198:201]
    ds_read_b64_tr_b16 v[34:35], v48 offset:2072
    ds_read_b64_tr_b16 v[36:37], v48 offset:3352
    v_mfma_f32_16x16x32_bf16 v[202:205], v[162:165], v[116:119], v[202:205]
    ds_read_b64_tr_b16 v[142:143], v48 offset:2080
    ds_read_b64_tr_b16 v[144:145], v48 offset:3360
    s_waitcnt lgkmcnt(10)
    v_mfma_f32_16x16x32_bf16 v[186:189], v[166:169], v[120:123], v[186:189]
    ds_read_b64_tr_b16 v[146:147], v48 offset:7168
    ds_read_b64_tr_b16 v[148:149], v48 offset:8448
    v_mfma_f32_16x16x32_bf16 v[190:193], v[170:173], v[120:123], v[190:193]
    ds_read_b64_tr_b16 v[150:151], v48 offset:7176
    ds_read_b64_tr_b16 v[152:153], v48 offset:8456
    v_mfma_f32_16x16x32_bf16 v[194:197], v[174:177], v[120:123], v[194:197]
    ds_read_b64_tr_b16 v[154:155], v48 offset:7184
    ds_read_b64_tr_b16 v[156:157], v48 offset:8464
    v_mfma_f32_16x16x32_bf16 v[198:201], v[178:181], v[120:123], v[198:201]
    ds_read_b64_tr_b16 v[158:159], v48 offset:7192
    ds_read_b64_tr_b16 v[160:161], v48 offset:8472
    v_mfma_f32_16x16x32_bf16 v[202:205], v[182:185], v[120:123], v[202:205]
    ds_read_b64_tr_b16 v[162:163], v48 offset:7200
    ds_read_b64_tr_b16 v[164:165], v48 offset:8480
    s_waitcnt lgkmcnt(10)
    v_mfma_f32_16x16x32_bf16 v[186:189], v[22:25], v[124:127], v[186:189]
    v_mfma_f32_16x16x32_bf16 v[190:193], v[26:29], v[124:127], v[190:193]
    v_mfma_f32_16x16x32_bf16 v[194:197], v[30:33], v[124:127], v[194:197]
    v_mfma_f32_16x16x32_bf16 v[198:201], v[34:37], v[124:127], v[198:201]
    v_mfma_f32_16x16x32_bf16 v[202:205], v[142:145], v[124:127], v[202:205]
    s_waitcnt lgkmcnt(0)
    v_mfma_f32_16x16x32_bf16 v[186:189], v[146:149], v[128:131], v[186:189]
    v_mfma_f32_16x16x32_bf16 v[190:193], v[150:153], v[128:131], v[190:193]
    v_mfma_f32_16x16x32_bf16 v[194:197], v[154:157], v[128:131], v[194:197]
    v_mfma_f32_16x16x32_bf16 v[198:201], v[158:161], v[128:131], v[198:201]
    v_mfma_f32_16x16x32_bf16 v[202:205], v[162:165], v[128:131], v[202:205]
    v_mov_b32 v176, 0
    v_mov_b32 v177, 0
    s_nop 1
    v_cvt_pk_bf16_f32 v166, v186, v187
    v_cvt_pk_bf16_f32 v167, v188, v189
    v_cvt_pk_bf16_f32 v168, v190, v191
    v_cvt_pk_bf16_f32 v169, v192, v193
    v_cvt_pk_bf16_f32 v170, v194, v195
    v_cvt_pk_bf16_f32 v171, v196, v197
    v_cvt_pk_bf16_f32 v172, v198, v199
    v_cvt_pk_bf16_f32 v173, v200, v201
    v_cvt_pk_bf16_f32 v174, v202, v203
    v_cvt_pk_bf16_f32 v175, v204, v205
    v_mfma_f32_16x16x32_bf16 v[186:189], a[196:199], v[166:169], 0
    v_mfma_f32_16x16x32_bf16 v[190:193], a[200:203], v[166:169], 0
    v_mfma_f32_16x16x32_bf16 v[194:197], a[204:207], v[166:169], 0
    v_mfma_f32_16x16x32_bf16 v[198:201], a[208:211], v[166:169], 0
    s_add_u32 s60, s76, 40960
    s_add_u32 m0, s58, 102400
    s_nop 0
    buffer_load_dwordx4 v8, s[12:15], s60 offen offset:0 sc1 lds
    v_mfma_f32_16x16x32_bf16 v[202:205], a[212:215], v[166:169], 0
    v_mfma_f32_16x16x32_bf16 v[186:189], a[216:219], v[170:173], v[186:189]
    v_mfma_f32_16x16x32_bf16 v[190:193], a[220:223], v[170:173], v[190:193]
    v_mfma_f32_16x16x32_bf16 v[194:197], a[224:227], v[170:173], v[194:197]
    v_mfma_f32_16x16x32_bf16 v[198:201], a[228:231], v[170:173], v[198:201]
    v_mfma_f32_16x16x32_bf16 v[202:205], a[232:235], v[170:173], v[202:205]
    buffer_load_dwordx4 v8, s[12:15], s60 offen offset:1024 sc1 lds
    v_mfma_f32_16x16x32_bf16 v[186:189], a[236:239], v[174:177], v[186:189]
    v_mfma_f32_16x16x32_bf16 v[190:193], a[240:243], v[174:177], v[190:193]
    v_mfma_f32_16x16x32_bf16 v[194:197], a[244:247], v[174:177], v[194:197]
    v_mfma_f32_16x16x32_bf16 v[198:201], a[248:251], v[174:177], v[198:201]
    v_mfma_f32_16x16x32_bf16 v[202:205], a[252:255], v[174:177], v[202:205]
    s_nop 3
    v_max3_f32 v18, v186, v187, v188
    v_min3_f32 v19, v186, v187, v188
    v_max3_f32 v18, v18, v189, v190
    v_min3_f32 v19, v19, v189, v190
    v_max3_f32 v18, v18, v191, v192
    v_min3_f32 v19, v19, v191, v192
    v_max3_f32 v18, v18, v193, v194
    v_min3_f32 v19, v19, v193, v194
    v_max3_f32 v18, v18, v195, v196
    v_min3_f32 v19, v19, v195, v196
    v_max3_f32 v18, v18, v197, v198
    v_min3_f32 v19, v19, v197, v198
    v_max3_f32 v18, v18, v199, v200
    v_min3_f32 v19, v19, v199, v200
    v_max3_f32 v18, v18, v201, v202
    v_min3_f32 v19, v19, v201, v202
    v_max3_f32 v18, v18, v203, v204
    v_min3_f32 v19, v19, v203, v204
    v_max_f32 v18, v18, v205
    v_min_f32 v19, v19, v205
    v_pk_mul_f32 v[18:19], v[18:19], s[68:69]
    v_pk_fma_f32 v[22:23], v[186:187], s[68:69], v[18:19] op_sel_hi:[1,1,0] neg_lo:[0,0,1] neg_hi:[0,0,1]
    v_pk_fma_f32 v[146:147], v[186:187], s[68:69], v[18:19] op_sel:[0,0,1] op_sel_hi:[1,1,1] neg_lo:[1,0,0] neg_hi:[1,0,0]
    buffer_load_dwordx4 v8, s[12:15], s60 offen offset:2048 sc1 lds
    v_pk_fma_f32 v[24:25], v[188:189], s[68:69], v[18:19] op_sel_hi:[1,1,0] neg_lo:[0,0,1] neg_hi:[0,0,1]
    v_pk_fma_f32 v[148:149], v[188:189], s[68:69], v[18:19] op_sel:[0,0,1] op_sel_hi:[1,1,1] neg_lo:[1,0,0] neg_hi:[1,0,0]
    v_pk_fma_f32 v[26:27], v[190:191], s[68:69], v[18:19] op_sel_hi:[1,1,0] neg_lo:[0,0,1] neg_hi:[0,0,1]
    v_pk_fma_f32 v[150:151], v[190:191], s[68:69], v[18:19] op_sel:[0,0,1] op_sel_hi:[1,1,1] neg_lo:[1,0,0] neg_hi:[1,0,0]
    v_pk_fma_f32 v[28:29], v[192:193], s[68:69], v[18:19] op_sel_hi:[1,1,0] neg_lo:[0,0,1] neg_hi:[0,0,1]
    v_pk_fma_f32 v[152:153], v[192:193], s[68:69], v[18:19] op_sel:[0,0,1] op_sel_hi:[1,1,1] neg_lo:[1,0,0] neg_hi:[1,0,0]
    buffer_load_dwordx4 v8, s[12:15], s60 offen offset:3072 sc1 lds
    v_pk_fma_f32 v[30:31], v[194:195], s[68:69], v[18:19] op_sel_hi:[1,1,0] neg_lo:[0,0,1] neg_hi:[0,0,1]
    v_pk_fma_f32 v[154:155], v[194:195], s[68:69], v[18:19] op_sel:[0,0,1] op_sel_hi:[1,1,1] neg_lo:[1,0,0] neg_hi:[1,0,0]
    v_pk_fma_f32 v[32:33], v[196:197], s[68:69], v[18:19] op_sel_hi:[1,1,0] neg_lo:[0,0,1] neg_hi:[0,0,1]
    v_pk_fma_f32 v[156:157], v[196:197], s[68:69], v[18:19] op_sel:[0,0,1] op_sel_hi:[1,1,1] neg_lo:[1,0,0] neg_hi:[1,0,0]
    v_pk_fma_f32 v[34:35], v[198:199], s[68:69], v[18:19] op_sel_hi:[1,1,0] neg_lo:[0,0,1] neg_hi:[0,0,1]
    v_pk_fma_f32 v[158:159], v[198:199], s[68:69], v[18:19] op_sel:[0,0,1] op_sel_hi:[1,1,1] neg_lo:[1,0,0] neg_hi:[1,0,0]
    v_pk_fma_f32 v[36:37], v[200:201], s[68:69], v[18:19] op_sel_hi:[1,1,0] neg_lo:[0,0,1] neg_hi:[0,0,1]
    v_pk_fma_f32 v[160:161], v[200:201], s[68:69], v[18:19] op_sel:[0,0,1] op_sel_hi:[1,1,1] neg_lo:[1,0,0] neg_hi:[1,0,0]
    v_pk_fma_f32 v[142:143], v[202:203], s[68:69], v[18:19] op_sel_hi:[1,1,0] neg_lo:[0,0,1] neg_hi:[0,0,1]
    v_pk_fma_f32 v[162:163], v[202:203], s[68:69], v[18:19] op_sel:[0,0,1] op_sel_hi:[1,1,1] neg_lo:[1,0,0] neg_hi:[1,0,0]
    v_pk_fma_f32 v[144:145], v[204:205], s[68:69], v[18:19] op_sel_hi:[1,1,0] neg_lo:[0,0,1] neg_hi:[0,0,1]
    v_pk_fma_f32 v[164:165], v[204:205], s[68:69], v[18:19] op_sel:[0,0,1] op_sel_hi:[1,1,1] neg_lo:[1,0,0] neg_hi:[1,0,0]
    v_exp_f32 v22, v22
    v_exp_f32 v23, v23
    v_exp_f32 v24, v24
    v_exp_f32 v25, v25
    v_exp_f32 v26, v26
    v_exp_f32 v27, v27
    s_add_u32 s60, s60, 4096
    s_add_u32 m0, s58, 106496
    s_nop 0
    buffer_load_dwordx4 v8, s[12:15], s60 offen offset:0 sc1 lds
    v_exp_f32 v28, v28
    v_exp_f32 v29, v29
    v_exp_f32 v30, v30
    v_exp_f32 v31, v31
    v_exp_f32 v32, v32
    v_exp_f32 v33, v33
    v_exp_f32 v34, v34
    v_exp_f32 v35, v35
    v_exp_f32 v36, v36
    v_exp_f32 v37, v37
    v_exp_f32 v142, v142
    s_add_u32 s60, s76, 61440
    s_add_u32 m0, s58, 0
    s_nop 0
    buffer_load_dwordx4 v8, s[12:15], s60 offen offset:0 sc1 lds
    v_exp_f32 v143, v143
    v_exp_f32 v144, v144
    v_exp_f32 v145, v145
    v_exp_f32 v146, v146
    v_exp_f32 v147, v147
    v_exp_f32 v148, v148
    v_exp_f32 v149, v149
    v_exp_f32 v150, v150
    v_exp_f32 v151, v151
    v_exp_f32 v152, v152
    v_exp_f32 v153, v153
    buffer_load_dwordx4 v8, s[12:15], s60 offen offset:1024 sc1 lds
    v_exp_f32 v154, v154
    v_exp_f32 v155, v155
    v_exp_f32 v156, v156
    v_exp_f32 v157, v157
    v_exp_f32 v158, v158
    v_exp_f32 v159, v159
    v_exp_f32 v160, v160
    v_exp_f32 v161, v161
    v_exp_f32 v162, v162
    v_exp_f32 v163, v163
    v_exp_f32 v164, v164
    v_exp_f32 v165, v165
    buffer_load_dwordx4 v8, s[12:15], s60 offen offset:2048 sc1 lds
    v_pk_add_f32 v[38:39], v[22:23], v[24:25]
    v_pk_add_f32 v[38:39], v[38:39], v[26:27]
    v_pk_add_f32 v[38:39], v[38:39], v[28:29]
    v_pk_add_f32 v[38:39], v[38:39], v[30:31]
    v_pk_add_f32 v[38:39], v[38:39], v[32:33]
    v_pk_add_f32 v[38:39], v[38:39], v[34:35]
    v_pk_add_f32 v[38:39], v[38:39], v[36:37]
    v_pk_add_f32 v[38:39], v[38:39], v[142:143]
    v_pk_add_f32 v[38:39], v[38:39], v[144:145]
    v_pk_add_f32 v[40:41], v[146:147], v[148:149]
    v_pk_add_f32 v[40:41], v[40:41], v[150:151]
    v_pk_add_f32 v[40:41], v[40:41], v[152:153]
    v_pk_add_f32 v[40:41], v[40:41], v[154:155]
    v_pk_add_f32 v[40:41], v[40:41], v[156:157]
    v_pk_add_f32 v[40:41], v[40:41], v[158:159]
    v_pk_add_f32 v[40:41], v[40:41], v[160:161]
    v_pk_add_f32 v[40:41], v[40:41], v[162:163]
    v_pk_add_f32 v[40:41], v[40:41], v[164:165]
    v_add_f32 v18, v38, v39
    v_add_f32 v19, v40, v41
    v_rcp_f32 v18, v18
    v_rcp_f32 v19, v19
    s_nop 0
    v_pk_mul_f32 v[22:23], v[22:23], v[18:19] op_sel_hi:[1,0]
    buffer_load_dwordx4 v8, s[12:15], s60 offen offset:3072 sc1 lds
    v_pk_mul_f32 v[24:25], v[24:25], v[18:19] op_sel_hi:[1,0]
    v_pk_mul_f32 v[26:27], v[26:27], v[18:19] op_sel_hi:[1,0]
    v_pk_mul_f32 v[28:29], v[28:29], v[18:19] op_sel_hi:[1,0]
    v_pk_mul_f32 v[30:31], v[30:31], v[18:19] op_sel_hi:[1,0]
    v_pk_mul_f32 v[32:33], v[32:33], v[18:19] op_sel_hi:[1,0]
    v_pk_mul_f32 v[34:35], v[34:35], v[18:19] op_sel_hi:[1,0]
    v_pk_mul_f32 v[36:37], v[36:37], v[18:19] op_sel_hi:[1,0]
    v_pk_mul_f32 v[142:143], v[142:143], v[18:19] op_sel_hi:[1,0]
    v_pk_mul_f32 v[144:145], v[144:145], v[18:19] op_sel_hi:[1,0]
    v_pk_mul_f32 v[146:147], v[146:147], v[18:19] op_sel:[0,1] op_sel_hi:[1,1]
    v_pk_mul_f32 v[148:149], v[148:149], v[18:19] op_sel:[0,1] op_sel_hi:[1,1]
    v_pk_mul_f32 v[150:151], v[150:151], v[18:19] op_sel:[0,1] op_sel_hi:[1,1]
    v_pk_mul_f32 v[152:153], v[152:153], v[18:19] op_sel:[0,1] op_sel_hi:[1,1]
    v_pk_mul_f32 v[154:155], v[154:155], v[18:19] op_sel:[0,1] op_sel_hi:[1,1]
    v_pk_mul_f32 v[156:157], v[156:157], v[18:19] op_sel:[0,1] op_sel_hi:[1,1]
    v_pk_mul_f32 v[158:159], v[158:159], v[18:19] op_sel:[0,1] op_sel_hi:[1,1]
    v_pk_mul_f32 v[160:161], v[160:161], v[18:19] op_sel:[0,1] op_sel_hi:[1,1]
    v_pk_mul_f32 v[162:163], v[162:163], v[18:19] op_sel:[0,1] op_sel_hi:[1,1]
    v_pk_mul_f32 v[164:165], v[164:165], v[18:19] op_sel:[0,1] op_sel_hi:[1,1]
    v_cvt_pk_bf16_f32 v186, v22, v23
    v_cvt_pk_bf16_f32 v187, v24, v25
    v_cvt_pk_bf16_f32 v188, v26, v27
    s_add_u32 s60, s60, 4096
    s_add_u32 m0, s58, 4096
    s_nop 0
    buffer_load_dwordx4 v8, s[12:15], s60 offen offset:0 sc1 lds
    v_cvt_pk_bf16_f32 v189, v28, v29
    v_cvt_pk_bf16_f32 v190, v30, v31
    v_cvt_pk_bf16_f32 v191, v32, v33
    v_cvt_pk_bf16_f32 v192, v34, v35
    v_cvt_pk_bf16_f32 v193, v36, v37
    v_cvt_pk_bf16_f32 v194, v142, v143
    v_cvt_pk_bf16_f32 v195, v144, v145
    v_cvt_pk_bf16_f32 v196, v146, v147
    v_cvt_pk_bf16_f32 v197, v148, v149
    v_cvt_pk_bf16_f32 v198, v150, v151
    v_cvt_pk_bf16_f32 v199, v152, v153
    v_cvt_pk_bf16_f32 v200, v154, v155
    v_cvt_pk_bf16_f32 v201, v156, v157
    v_cvt_pk_bf16_f32 v202, v158, v159
    v_cvt_pk_bf16_f32 v203, v160, v161
    v_cvt_pk_bf16_f32 v204, v162, v163
    v_cvt_pk_bf16_f32 v205, v164, v165
    s_lshl_b32 s56, s3, 4
    v_add_u32 v14, s56, v3
    v_mul_u32_u24 v14, 544, v14
    v_mul_u32_u24 v13, 80, v2
    v_add_u32 v13, v13, v14
    ds_write_b128 v13, v[186:189] offset:40960
    ds_write_b128 v13, v[190:193] offset:40976
    ds_write_b128 v13, v[194:197] offset:40992
    ds_write_b128 v13, v[198:201] offset:41008
    ds_write_b128 v13, v[202:205] offset:41024
    s_waitcnt vmcnt(15)
    s_barrier
    ds_read_b128 v[22:25], v51 offset:12288
    ds_read_b128 v[26:29], v51 offset:13312
    ds_read_b128 v[30:33], v51 offset:14336
    ds_read_b128 v[34:37], v51 offset:15360
    ds_read_b128 v[142:145], v51 offset:16384
    ds_read_b128 v[146:149], v51 offset:17408
    ds_read_b128 v[150:153], v51 offset:18432
    ds_read_b128 v[154:157], v51 offset:19456
    ds_read_b128 v[158:161], v51 offset:20480
    ds_read_b128 v[162:165], v51 offset:21504
    s_waitcnt lgkmcnt(5)
    v_mfma_f32_16x16x32_bf16 v[186:189], v[22:25], v[52:55], 0
    ds_read_b128 v[166:169], v51 offset:22528
    s_add_u32 s60, s76, 81920
    s_add_u32 m0, s58, 20480
    s_nop 0
    buffer_load_dwordx4 v8, s[12:15], s60 offen offset:0 sc1 lds
    v_mfma_f32_16x16x32_bf16 v[190:193], v[26:29], v[52:55], 0
    ds_read_b128 v[170:173], v51 offset:23552
    buffer_load_dwordx4 v8, s[12:15], s60 offen offset:1024 sc1 lds
    v_mfma_f32_16x16x32_bf16 v[194:197], v[30:33], v[52:55], 0
    ds_read_b128 v[174:177], v51 offset:24576
    v_mfma_f32_16x16x32_bf16 v[198:201], v[34:37], v[52:55], 0
    ds_read_b128 v[178:181], v51 offset:25600
    v_mfma_f32_16x16x32_bf16 v[202:205], v[142:145], v[52:55], 0
    ds_read_b128 v[182:185], v51 offset:26624
    buffer_load_dwordx4 v8, s[12:15], s60 offen offset:2048 sc1 lds
    s_waitcnt lgkmcnt(5)
    v_mfma_f32_16x16x32_bf16 v[186:189], v[146:149], v[56:59], v[186:189]
    ds_read_b128 v[22:25], v51 offset:27648
    v_mfma_f32_16x16x32_bf16 v[190:193], v[150:153], v[56:59], v[190:193]
    ds_read_b128 v[26:29], v51 offset:28672
    v_mfma_f32_16x16x32_bf16 v[194:197], v[154:157], v[56:59], v[194:197]
    ds_read_b128 v[30:33], v51 offset:29696
    buffer_load_dwordx4 v8, s[12:15], s60 offen offset:3072 sc1 lds
    v_mfma_f32_16x16x32_bf16 v[198:201], v[158:161], v[56:59], v[198:201]
    ds_read_b128 v[34:37], v51 offset:30720
    v_mfma_f32_16x16x32_bf16 v[202:205], v[162:165], v[56:59], v[202:205]
    ds_read_b128 v[142:145], v51 offset:31744
    s_waitcnt vmcnt(14)
    s_barrier
    s_waitcnt lgkmcnt(5)
    v_mfma_f32_16x16x32_bf16 v[186:189], v[166:169], v[60:63], v[186:189]
    ds_read_b128 v[146:149], v50 offset:16384
    s_add_u32 s60, s60, 4096
    s_add_u32 m0, s58, 24576
    s_nop 0
    buffer_load_dwordx4 v8, s[12:15], s60 offen offset:0 sc1 lds
    v_mfma_f32_16x16x32_bf16 v[190:193], v[170:173], v[60:63], v[190:193]
    ds_read_b128 v[150:153], v50 offset:17408
    v_mfma_f32_16x16x32_bf16 v[194:197], v[174:177], v[60:63], v[194:197]
    ds_read_b128 v[154:157], v50 offset:18432
    v_mfma_f32_16x16x32_bf16 v[198:201], v[178:181], v[60:63], v[198:201]
    ds_read_b128 v[158:161], v50 offset:19456
    s_add_u32 s60, s75, 1048576
    s_add_u32 m0, s58, 122880
    s_nop 0
    buffer_load_dwordx4 v8, s[12:15], s60 offen offset:0 sc1 lds
    v_mfma_f32_16x16x32_bf16 v[202:205], v[182:185], v[60:63], v[202:205]
    ds_read_b128 v[162:165], v50 offset:20480
    s_waitcnt lgkmcnt(5)
    v_mfma_f32_16x16x32_bf16 v[186:189], v[22:25], v[64:67], v[186:189]
    ds_read_b128 v[166:169], v50 offset:21504
    v_mfma_f32_16x16x32_bf16 v[190:193], v[26:29], v[64:67], v[190:193]
    ds_read_b128 v[170:173], v50 offset:22528
    buffer_load_dwordx4 v8, s[12:15], s60 offen offset:1024 sc1 lds
    v_mfma_f32_16x16x32_bf16 v[194:197], v[30:33], v[64:67], v[194:197]
    ds_read_b128 v[174:177], v50 offset:23552
    v_mfma_f32_16x16x32_bf16 v[198:201], v[34:37], v[64:67], v[198:201]
    ds_read_b128 v[178:181], v50 offset:24576
    v_mfma_f32_16x16x32_bf16 v[202:205], v[142:145], v[64:67], v[202:205]
    ds_read_b128 v[182:185], v50 offset:25600
    s_waitcnt lgkmcnt(5)
    v_mfma_f32_16x16x32_bf16 v[186:189], v[146:149], v[68:71], v[186:189]
    ds_read_b128 v[22:25], v50 offset:26624
    buffer_load_dwordx4 v8, s[12:15], s60 offen offset:2048 sc1 lds
    v_mfma_f32_16x16x32_bf16 v[190:193], v[150:153], v[68:71], v[190:193]
    ds_read_b128 v[26:29], v50 offset:27648
    v_mfma_f32_16x16x32_bf16 v[194:197], v[154:157], v[68:71], v[194:197]
    ds_read_b128 v[30:33], v50 offset:28672
    v_mfma_f32_16x16x32_bf16 v[198:201], v[158:161], v[68:71], v[198:201]
    ds_read_b128 v[34:37], v50 offset:29696
    buffer_load_dwordx4 v8, s[12:15], s60 offen offset:3072 sc1 lds
    v_mfma_f32_16x16x32_bf16 v[202:205], v[162:165], v[68:71], v[202:205]
    ds_read_b128 v[142:145], v50 offset:30720
    s_waitcnt lgkmcnt(5)
    v_mfma_f32_16x16x32_bf16 v[186:189], v[166:169], v[72:75], v[186:189]
    ds_read_b128 v[146:149], v50 offset:31744
    v_mfma_f32_16x16x32_bf16 v[190:193], v[170:173], v[72:75], v[190:193]
    ds_read_b128 v[150:153], v50 offset:32768
    v_mfma_f32_16x16x32_bf16 v[194:197], v[174:177], v[72:75], v[194:197]
    ds_read_b128 v[154:157], v50 offset:33792
    s_add_u32 s60, s60, 4096
    s_add_u32 m0, s58, 126976
    s_nop 0
    buffer_load_dwordx4 v8, s[12:15], s60 offen offset:0 sc1 lds
    v_mfma_f32_16x16x32_bf16 v[198:201], v[178:181], v[72:75], v[198:201]
    ds_read_b128 v[158:161], v50 offset:34816
    v_mfma_f32_16x16x32_bf16 v[202:205], v[182:185], v[72:75], v[202:205]
    ds_read_b128 v[162:165], v50 offset:35840
    s_waitcnt vmcnt(15)
    s_barrier
    s_waitcnt lgkmcnt(5)
    v_mfma_f32_16x16x32_bf16 v[186:189], v[22:25], v[76:79], v[186:189]
    ds_read_b128 v[166:169], v50 offset:36864
    s_add_u32 s60, s75, 1069056
    s_add_u32 m0, s58, 143360
    s_nop 0
    buffer_load_dwordx4 v8, s[12:15], s60 offen offset:0 sc1 lds
    v_mfma_f32_16x16x32_bf16 v[190:193], v[26:29], v[76:79], v[190:193]
    ds_read_b128 v[170:173], v50 offset:37888
    v_mfma_f32_16x16x32_bf16 v[194:197], v[30:33], v[76:79], v[194:197]
    ds_read_b128 v[174:177], v50 offset:38912
    v_mfma_f32_16x16x32_bf16 v[198:201], v[34:37], v[76:79], v[198:201]
    ds_read_b128 v[178:181], v50 offset:39936
    buffer_load_dwordx4 v8, s[12:15], s60 offen offset:1024 sc1 lds
    v_mfma_f32_16x16x32_bf16 v[202:205], v[142:145], v[76:79], v[202:205]
    ds_read_b128 v[182:185], v50 offset:40960
    s_waitcnt lgkmcnt(5)
    v_mfma_f32_16x16x32_bf16 v[186:189], v[146:149], v[80:83], v[186:189]
    ds_read_b128 v[22:25], v50 offset:41984
    v_mfma_f32_16x16x32_bf16 v[190:193], v[150:153], v[80:83], v[190:193]
    ds_read_b128 v[26:29], v50 offset:43008
    buffer_load_dwordx4 v8, s[12:15], s60 offen offset:2048 sc1 lds
    v_mfma_f32_16x16x32_bf16 v[194:197], v[154:157], v[80:83], v[194:197]
    ds_read_b128 v[30:33], v50 offset:44032
    v_mfma_f32_16x16x32_bf16 v[198:201], v[158:161], v[80:83], v[198:201]
    ds_read_b128 v[34:37], v50 offset:45056
    v_mfma_f32_16x16x32_bf16 v[202:205], v[162:165], v[80:83], v[202:205]
    ds_read_b128 v[142:145], v50 offset:46080
    buffer_load_dwordx4 v8, s[12:15], s60 offen offset:3072 sc1 lds
    s_waitcnt lgkmcnt(5)
    v_mfma_f32_16x16x32_bf16 v[186:189], v[166:169], v[84:87], v[186:189]
    ds_read_b128 v[146:149], v50 offset:47104
    v_mfma_f32_16x16x32_bf16 v[190:193], v[170:173], v[84:87], v[190:193]
    ds_read_b128 v[150:153], v50 offset:48128
    v_mfma_f32_16x16x32_bf16 v[194:197], v[174:177], v[84:87], v[194:197]
    ds_read_b128 v[154:157], v50 offset:49152
    v_mfma_f32_16x16x32_bf16 v[198:201], v[178:181], v[84:87], v[198:201]
    ds_read_b128 v[158:161], v50 offset:50176
    s_add_u32 s60, s60, 4096
    s_add_u32 m0, s58, 147456
    s_nop 0
    buffer_load_dwordx4 v8, s[12:15], s60 offen offset:0 sc1 lds
    v_mfma_f32_16x16x32_bf16 v[202:205], v[182:185], v[84:87], v[202:205]
    ds_read_b128 v[162:165], v50 offset:51200
    s_waitcnt lgkmcnt(5)
    v_mfma_f32_16x16x32_bf16 v[186:189], v[22:25], v[88:91], v[186:189]
    ds_read_b128 v[166:169], v50 offset:52224
    v_mfma_f32_16x16x32_bf16 v[190:193], v[26:29], v[88:91], v[190:193]
    ds_read_b128 v[170:173], v50 offset:53248
    v_mfma_f32_16x16x32_bf16 v[194:197], v[30:33], v[88:91], v[194:197]
    ds_read_b128 v[174:177], v50 offset:54272
    v_mfma_f32_16x16x32_bf16 v[198:201], v[34:37], v[88:91], v[198:201]
    ds_read_b128 v[178:181], v50 offset:55296
    v_mfma_f32_16x16x32_bf16 v[202:205], v[142:145], v[88:91], v[202:205]
    ds_read_b128 v[182:185], v50 offset:56320
    s_waitcnt vmcnt(15)
    s_barrier
    s_waitcnt lgkmcnt(5)
    v_mfma_f32_16x16x32_bf16 v[186:189], v[146:149], v[92:95], v[186:189]
    ds_read_b128 v[22:25], v49 offset:0
    s_add_u32 s60, s76, 1089536
    s_add_u32 m0, s58, 81920
    s_nop 0
    buffer_load_dwordx4 v8, s[12:15], s60 offen offset:0 sc1 lds
    v_mfma_f32_16x16x32_bf16 v[190:193], v[150:153], v[92:95], v[190:193]
    ds_read_b128 v[26:29], v49 offset:1024
    buffer_load_dwordx4 v8, s[12:15], s60 offen offset:1024 sc1 lds
    v_mfma_f32_16x16x32_bf16 v[194:197], v[154:157], v[92:95], v[194:197]
    ds_read_b128 v[30:33], v49 offset:2048
    buffer_load_dwordx4 v8, s[12:15], s60 offen offset:2048 sc1 lds
    v_mfma_f32_16x16x32_bf16 v[198:201], v[158:161], v[92:95], v[198:201]
    ds_read_b128 v[34:37], v49 offset:3072
    v_mfma_f32_16x16x32_bf16 v[202:205], v[162:165], v[92:95], v[202:205]
    ds_read_b128 v[142:145], v49 offset:4096
    s_waitcnt lgkmcnt(5)
    v_mfma_f32_16x16x32_bf16 v[186:189], v[166:169], v[96:99], v[186:189]
    ds_read_b128 v[146:149], v49 offset:5120
    v_mfma_f32_16x16x32_bf16 v[190:193], v[170:173], v[96:99], v[190:193]
    ds_read_b128 v[150:153], v49 offset:6144
    buffer_load_dwordx4 v8, s[12:15], s60 offen offset:3072 sc1 lds
    v_mfma_f32_16x16x32_bf16 v[194:197], v[174:177], v[96:99], v[194:197]
    ds_read_b128 v[154:157], v49 offset:7168
    v_mfma_f32_16x16x32_bf16 v[198:201], v[178:181], v[96:99], v[198:201]
    ds_read_b128 v[158:161], v49 offset:8192
    v_mfma_f32_16x16x32_bf16 v[202:205], v[182:185], v[96:99], v[202:205]
    ds_read_b128 v[162:165], v49 offset:9216
    s_add_u32 s60, s60, 4096
    s_add_u32 m0, s58, 86016
    s_nop 0
    buffer_load_dwordx4 v8, s[12:15], s60 offen offset:0 sc1 lds
    s_waitcnt lgkmcnt(5)
    v_mfma_f32_16x16x32_bf16 v[186:189], v[22:25], v[100:103], v[186:189]
    ds_read_b128 v[166:169], v49 offset:10240
    v_mfma_f32_16x16x32_bf16 v[190:193], v[26:29], v[100:103], v[190:193]
    ds_read_b128 v[170:173], v49 offset:11264
    v_mfma_f32_16x16x32_bf16 v[194:197], v[30:33], v[100:103], v[194:197]
    ds_read_b128 v[174:177], v49 offset:12288
    v_mfma_f32_16x16x32_bf16 v[198:201], v[34:37], v[100:103], v[198:201]
    ds_read_b128 v[178:181], v49 offset:13312
    v_mfma_f32_16x16x32_bf16 v[202:205], v[142:145], v[100:103], v[202:205]
    ds_read_b128 v[182:185], v49 offset:14336
    s_waitcnt lgkmcnt(5)
    v_mfma_f32_16x16x32_bf16 v[186:189], v[146:149], v[104:107], v[186:189]
    ds_read_b128 v[22:25], v49 offset:15360
    v_mfma_f32_16x16x32_bf16 v[190:193], v[150:153], v[104:107], v[190:193]
    ds_read_b128 v[26:29], v49 offset:16384
    v_mfma_f32_16x16x32_bf16 v[194:197], v[154:157], v[104:107], v[194:197]
    ds_read_b128 v[30:33], v49 offset:17408
    v_mfma_f32_16x16x32_bf16 v[198:201], v[158:161], v[104:107], v[198:201]
    ds_read_b128 v[34:37], v49 offset:18432
    v_mfma_f32_16x16x32_bf16 v[202:205], v[162:165], v[104:107], v[202:205]
    ds_read_b128 v[142:145], v49 offset:19456
    s_waitcnt vmcnt(15)
    s_barrier
    s_mul_i32 s77, s61, 25600
    s_add_u32 s77, s77, 0x0
    s_mul_i32 s78, s61, 61440
    s_add_u32 s78, s78, 0x100000
    s_waitcnt lgkmcnt(5)
    v_mfma_f32_16x16x32_bf16 v[186:189], v[166:169], v[108:111], v[186:189]
    ds_read_b128 v[146:149], v49 offset:20480
    s_add_u32 s60, s76, 1110016
    s_add_u32 m0, s58, 102400
    s_nop 0
    buffer_load_dwordx4 v8, s[12:15], s60 offen offset:0 sc1 lds
    v_mfma_f32_16x16x32_bf16 v[190:193], v[170:173], v[108:111], v[190:193]
    ds_read_b128 v[150:153], v49 offset:21504
    buffer_load_dwordx4 v8, s[12:15], s60 offen offset:1024 sc1 lds
    v_mfma_f32_16x16x32_bf16 v[194:197], v[174:177], v[108:111], v[194:197]
    ds_read_b128 v[154:157], v49 offset:22528
    buffer_load_dwordx4 v8, s[12:15], s60 offen offset:2048 sc1 lds
    v_mfma_f32_16x16x32_bf16 v[198:201], v[178:181], v[108:111], v[198:201]
    ds_read_b128 v[158:161], v49 offset:23552
    buffer_load_dwordx4 v8, s[12:15], s60 offen offset:3072 sc1 lds
    v_mfma_f32_16x16x32_bf16 v[202:205], v[182:185], v[108:111], v[202:205]
    ds_read_b128 v[162:165], v49 offset:24576
    s_add_u32 s60, s60, 4096
    s_add_u32 m0, s58, 106496
    s_nop 0
    buffer_load_dwordx4 v8, s[12:15], s60 offen offset:0 sc1 lds
    s_waitcnt lgkmcnt(5)
    v_mfma_f32_16x16x32_bf16 v[186:189], v[22:25], v[112:115], v[186:189]
    ds_read_b128 v[166:169], v49 offset:25600
    v_mfma_f32_16x16x32_bf16 v[190:193], v[26:29], v[112:115], v[190:193]
    ds_read_b128 v[170:173], v49 offset:26624
    v_mfma_f32_16x16x32_bf16 v[194:197], v[30:33], v[112:115], v[194:197]
    ds_read_b128 v[174:177], v49 offset:27648
    buffer_load_dwordx4 a[0:3], v8, s[12:15], s77 offen offset:0 sc1
    v_mfma_f32_16x16x32_bf16 v[198:201], v[34:37], v[112:115], v[198:201]
    ds_read_b128 v[178:181], v49 offset:28672
    v_mfma_f32_16x16x32_bf16 v[202:205], v[142:145], v[112:115], v[202:205]
    ds_read_b128 v[182:185], v49 offset:29696
    s_waitcnt lgkmcnt(5)
    v_mfma_f32_16x16x32_bf16 v[186:189], v[146:149], v[116:119], v[186:189]
    ds_read_b128 v[22:25], v49 offset:30720
    v_mfma_f32_16x16x32_bf16 v[190:193], v[150:153], v[116:119], v[190:193]
    ds_read_b128 v[26:29], v49 offset:31744
    buffer_load_dwordx4 a[4:7], v8, s[12:15], s77 offen offset:1024 sc1
    v_mfma_f32_16x16x32_bf16 v[194:197], v[154:157], v[116:119], v[194:197]
    ds_read_b128 v[30:33], v49 offset:32768
    v_mfma_f32_16x16x32_bf16 v[198:201], v[158:161], v[116:119], v[198:201]
    ds_read_b128 v[34:37], v49 offset:33792
    v_mfma_f32_16x16x32_bf16 v[202:205], v[162:165], v[116:119], v[202:205]
    ds_read_b128 v[142:145], v49 offset:34816
    buffer_load_dwordx4 a[8:11], v8, s[12:15], s77 offen offset:2048 sc1
    s_waitcnt lgkmcnt(5)
    v_mfma_f32_16x16x32_bf16 v[186:189], v[166:169], v[120:123], v[186:189]
    ds_read_b128 v[146:149], v49 offset:35840
    v_mfma_f32_16x16x32_bf16 v[190:193], v[170:173], v[120:123], v[190:193]
    ds_read_b128 v[150:153], v49 offset:36864
    v_mfma_f32_16x16x32_bf16 v[194:197], v[174:177], v[120:123], v[194:197]
    ds_read_b128 v[154:157], v49 offset:37888
    v_mfma_f32_16x16x32_bf16 v[198:201], v[178:181], v[120:123], v[198:201]
    ds_read_b128 v[158:161], v49 offset:38912
    buffer_load_dwordx4 a[12:15], v8, s[12:15], s77 offen offset:3072 sc1
    v_mfma_f32_16x16x32_bf16 v[202:205], v[182:185], v[120:123], v[202:205]
    ds_read_b128 v[162:165], v49 offset:39936
    s_waitcnt lgkmcnt(5)
    v_mfma_f32_16x16x32_bf16 v[186:189], v[22:25], v[124:127], v[186:189]
    v_mfma_f32_16x16x32_bf16 v[190:193], v[26:29], v[124:127], v[190:193]
    s_add_u32 s77, s77, 4096
    buffer_load_dwordx4 a[16:19], v8, s[12:15], s77 offen offset:0 sc1
    v_mfma_f32_16x16x32_bf16 v[194:197], v[30:33], v[124:127], v[194:197]
    v_mfma_f32_16x16x32_bf16 v[198:201], v[34:37], v[124:127], v[198:201]
    v_mfma_f32_16x16x32_bf16 v[202:205], v[142:145], v[124:127], v[202:205]
    s_waitcnt lgkmcnt(0)
    v_mfma_f32_16x16x32_bf16 v[186:189], v[146:149], v[128:131], v[186:189]
    buffer_load_dwordx4 a[20:23], v8, s[12:15], s77 offen offset:1024 sc1
    v_mfma_f32_16x16x32_bf16 v[190:193], v[150:153], v[128:131], v[190:193]
    v_mfma_f32_16x16x32_bf16 v[194:197], v[154:157], v[128:131], v[194:197]
    v_mfma_f32_16x16x32_bf16 v[198:201], v[158:161], v[128:131], v[198:201]
    buffer_load_dwordx4 a[24:27], v8, s[12:15], s77 offen offset:2048 sc1
    v_mfma_f32_16x16x32_bf16 v[202:205], v[162:165], v[128:131], v[202:205]
    v_mul_u32_u24 v18, 544, v17
    v_lshl_add_u32 v18, v5, 3, v18
    s_mul_i32 s56, s3, 48
    s_add_u32 s56, s56, 41280
    v_add_u32 v19, s56, v18
    s_mul_i32 s56, s3, 80
    s_add_u32 s56, s56, 40960
    v_add_u32 v18, s56, v18
    ds_read_b64_tr_b16 v[22:23], v18 offset:0
    ds_read_b64_tr_b16 v[24:25], v18 offset:4352
    ds_read_b64_tr_b16 v[26:27], v18 offset:32
    ds_read_b64_tr_b16 v[28:29], v18 offset:4384
    ds_read_b64_tr_b16 v[30:31], v18 offset:64
    ds_read_b64_tr_b16 v[32:33], v18 offset:4416
    ds_read_b64_tr_b16 v[34:35], v18 offset:17408
    ds_read_b64_tr_b16 v[36:37], v18 offset:21760
    ds_read_b64_tr_b16 v[142:143], v18 offset:17440
    ds_read_b64_tr_b16 v[144:145], v18 offset:21792
    ds_read_b64_tr_b16 v[146:147], v18 offset:17472
    ds_read_b64_tr_b16 v[148:149], v18 offset:21824
    s_mul_i32 s56, s3, 2592
    s_add_u32 s56, s56, 20480
    v_add_u32 v21, s56, v8
    v_mul_u32_u24 v20, 80, v3
    v_lshl_add_u32 v20, v2, 3, v20
    v_add_u32 v20, s56, v20
    v_mov_b32 v208, 0x3f80
    v_mov_b32 v209, 0
    v_mad_u32_u24 v13, v2, 48, v14
    v_cvt_pk_bf16_f32 v38, v186, v187
    buffer_load_dwordx4 a[28:31], v8, s[12:15], s77 offen offset:3072 sc1
    v_cvt_pk_bf16_f32 v39, v188, v189
    s_add_u32 s77, s77, 4096
    buffer_load_dwordx4 a[32:35], v8, s[12:15], s77 offen offset:0 sc1
    v_cvt_pk_bf16_f32 v40, v190, v191
    buffer_load_dwordx4 a[36:39], v8, s[12:15], s77 offen offset:1024 sc1
    v_cvt_pk_bf16_f32 v41, v192, v193
    buffer_load_dwordx4 a[40:43], v8, s[12:15], s77 offen offset:2048 sc1
    v_cvt_pk_bf16_f32 v42, v194, v195
    buffer_load_dwordx4 a[44:47], v8, s[12:15], s77 offen offset:3072 sc1
    v_cvt_pk_bf16_f32 v43, v196, v197
    v_cvt_pk_bf16_f32 v44, v198, v199
    v_cvt_pk_bf16_f32 v45, v200, v201
    v_cvt_pk_bf16_f32 v206, v202, v203
    v_cvt_pk_bf16_f32 v207, v204, v205
    ds_write_b128 v13, v[38:41] offset:41280
    ds_write_b128 v13, v[42:45] offset:41296
    ds_write_b128 v13, v[206:209] offset:41312
    s_waitcnt lgkmcnt(0)
    s_barrier
    ds_read_b64_tr_b16 v[150:151], v19 offset:0
    ds_read_b64_tr_b16 v[152:153], v19 offset:4352
    ds_read_b64_tr_b16 v[154:155], v19 offset:32
    ds_read_b64_tr_b16 v[156:157], v19 offset:4384
    ds_read_b64_tr_b16 v[158:159], v19 offset:17408
    ds_read_b64_tr_b16 v[160:161], v19 offset:21760
    ds_read_b64_tr_b16 v[162:163], v19 offset:17440
    ds_read_b64_tr_b16 v[164:165], v19 offset:21792
    s_waitcnt lgkmcnt(6)
    v_mfma_f32_16x16x32_bf16 v[214:217], v[30:33], v[150:153], 0
    s_add_u32 s77, s77, 4096
    buffer_load_dwordx4 a[48:51], v8, s[12:15], s77 offen offset:0 sc1
    s_waitcnt lgkmcnt(4)
    v_mfma_f32_16x16x32_bf16 v[218:221], v[30:33], v[154:157], 0
    buffer_load_dwordx4 a[52:55], v8, s[12:15], s77 offen offset:1024 sc1
    v_mfma_f32_16x16x32_bf16 v[38:41], v[22:25], v[150:153], 0
    buffer_load_dwordx4 a[56:59], v8, s[12:15], s77 offen offset:2048 sc1
    v_mfma_f32_16x16x32_bf16 v[42:45], v[22:25], v[154:157], 0
    v_mfma_f32_16x16x32_bf16 v[206:209], v[26:29], v[150:153], 0
    v_mfma_f32_16x16x32_bf16 v[210:213], v[26:29], v[154:157], 0
    s_waitcnt lgkmcnt(2)
    v_mfma_f32_16x16x32_bf16 v[214:217], v[146:149], v[158:161], v[214:217]
    s_waitcnt lgkmcnt(0)
    v_mfma_f32_16x16x32_bf16 v[218:221], v[146:149], v[162:165], v[218:221]
    v_mfma_f32_16x16x32_bf16 v[38:41], v[34:37], v[158:161], v[38:41]
    v_mfma_f32_16x16x32_bf16 v[42:45], v[34:37], v[162:165], v[42:45]
    v_mfma_f32_16x16x32_bf16 v[206:209], v[142:145], v[158:161], v[206:209]
    v_mfma_f32_16x16x32_bf16 v[210:213], v[142:145], v[162:165], v[210:213]
    s_nop 1
    v_cvt_pk_bf16_f32 v166, v214, v215
    v_cvt_pk_bf16_f32 v167, v216, v217
    ds_write_b64 v20, v[166:167] offset:64
    v_cvt_pk_bf16_f32 v168, v218, v219
    v_cvt_pk_bf16_f32 v169, v220, v221
    ds_write_b64 v20, v[168:169] offset:1344
    v_cvt_pk_bf16_f32 v170, v38, v39
    v_cvt_pk_bf16_f32 v171, v40, v41
    ds_write_b64 v20, v[170:171] offset:0
    v_cvt_pk_bf16_f32 v172, v42, v43
    v_cvt_pk_bf16_f32 v173, v44, v45
    ds_write_b64 v20, v[172:173] offset:1280
    v_cvt_pk_bf16_f32 v174, v206, v207
    v_cvt_pk_bf16_f32 v175, v208, v209
    ds_write_b64 v20, v[174:175] offset:32
    v_cvt_pk_bf16_f32 v176, v210, v211
    v_cvt_pk_bf16_f32 v177, v212, v213
    ds_write_b64 v20, v[176:177] offset:1312
    ds_read_b128 v[38:41], v21
    ds_read_b128 v[42:45], v21 offset:1024
    s_waitcnt lgkmcnt(1)
    buffer_store_dwordx4 v[38:41], v8, s[12:15], s72 offen sc1
    s_waitcnt lgkmcnt(0)
    buffer_store_dwordx4 v[42:45], v15, s[12:15], s72 offen offset:1024 sc1
    s_add_u32 s60, s76, 1130496
    s_add_u32 m0, s58, 0
    s_nop 0
    buffer_load_dwordx4 v8, s[12:15], s60 offen offset:0 sc1 lds
    buffer_load_dwordx4 v8, s[12:15], s60 offen offset:1024 sc1 lds
    buffer_load_dwordx4 v8, s[12:15], s60 offen offset:2048 sc1 lds
    buffer_load_dwordx4 v8, s[12:15], s60 offen offset:3072 sc1 lds
    s_add_u32 s60, s60, 4096
    s_add_u32 m0, s58, 4096
    s_nop 0
    buffer_load_dwordx4 v8, s[12:15], s60 offen offset:0 sc1 lds
    s_waitcnt vmcnt(37)
    s_barrier
    ds_read_b128 v[22:25], v50 offset:57344
    ds_read_b128 v[26:29], v50 offset:58368
    ds_read_b128 v[30:33], v50 offset:59392
    ds_read_b128 v[34:37], v50 offset:60416
    ds_read_b128 v[142:145], v50 offset:61440
    ds_read_b128 v[146:149], v50 offset:62464
    ds_read_b128 v[150:153], v50 offset:63488
    ds_read_b128 v[154:157], v50 offset:64512
    ds_read_b128 v[158:161], v51 offset:0
    ds_read_b128 v[162:165], v51 offset:1024
    s_waitcnt lgkmcnt(5)
    v_mfma_f32_16x16x32_bf16 v[186:189], v[22:25], v[52:55], 0
    ds_read_b128 v[166:169], v51 offset:2048
    buffer_load_dwordx4 a[60:63], v8, s[12:15], s77 offen offset:3072 sc1
    v_mfma_f32_16x16x32_bf16 v[190:193], v[26:29], v[52:55], 0
    ds_read_b128 v[170:173], v51 offset:3072
    s_add_u32 s77, s77, 4096
    buffer_load_dwordx4 a[64:67], v8, s[12:15], s77 offen offset:0 sc1
    v_mfma_f32_16x16x32_bf16 v[194:197], v[30:33], v[52:55], 0
    ds_read_b128 v[174:177], v51 offset:4096
    v_mfma_f32_16x16x32_bf16 v[198:201], v[34:37], v[52:55], 0
    ds_read_b128 v[178:181], v51 offset:5120
    v_mfma_f32_16x16x32_bf16 v[202:205], v[142:145], v[52:55], 0
    ds_read_b128 v[182:185], v51 offset:6144
    buffer_load_dwordx4 a[68:71], v8, s[12:15], s77 offen offset:1024 sc1
    s_waitcnt lgkmcnt(5)
    v_mfma_f32_16x16x32_bf16 v[186:189], v[146:149], v[56:59], v[186:189]
    ds_read_b128 v[22:25], v51 offset:7168
    v_mfma_f32_16x16x32_bf16 v[190:193], v[150:153], v[56:59], v[190:193]
    ds_read_b128 v[26:29], v51 offset:8192
    v_mfma_f32_16x16x32_bf16 v[194:197], v[154:157], v[56:59], v[194:197]
    ds_read_b128 v[30:33], v51 offset:9216
    buffer_load_dwordx4 a[72:75], v8, s[12:15], s77 offen offset:2048 sc1
    v_mfma_f32_16x16x32_bf16 v[198:201], v[158:161], v[56:59], v[198:201]
    ds_read_b128 v[34:37], v51 offset:10240
    v_mfma_f32_16x16x32_bf16 v[202:205], v[162:165], v[56:59], v[202:205]
    ds_read_b128 v[142:145], v51 offset:11264
    s_waitcnt vmcnt(36)
    s_barrier
    s_waitcnt lgkmcnt(5)
    v_mfma_f32_16x16x32_bf16 v[186:189], v[166:169], v[60:63], v[186:189]
    ds_read_b128 v[146:149], v51 offset:12288
    buffer_load_dwordx4 a[76:79], v8, s[12:15], s77 offen offset:3072 sc1
    v_mfma_f32_16x16x32_bf16 v[190:193], v[170:173], v[60:63], v[190:193]
    ds_read_b128 v[150:153], v51 offset:13312
    v_mfma_f32_16x16x32_bf16 v[194:197], v[174:177], v[60:63], v[194:197]
    ds_read_b128 v[154:157], v51 offset:14336
    v_mfma_f32_16x16x32_bf16 v[198:201], v[178:181], v[60:63], v[198:201]
    ds_read_b128 v[158:161], v51 offset:15360
    s_add_u32 s77, s77, 4096
    buffer_load_dwordx4 a[80:83], v8, s[12:15], s77 offen offset:0 sc1
    v_mfma_f32_16x16x32_bf16 v[202:205], v[182:185], v[60:63], v[202:205]
    ds_read_b128 v[162:165], v51 offset:16384
    s_waitcnt lgkmcnt(5)
    v_mfma_f32_16x16x32_bf16 v[186:189], v[22:25], v[64:67], v[186:189]
    ds_read_b128 v[166:169], v51 offset:17408
    v_mfma_f32_16x16x32_bf16 v[190:193], v[26:29], v[64:67], v[190:193]
    ds_read_b128 v[170:173], v51 offset:18432
    buffer_load_dwordx4 a[84:87], v8, s[12:15], s77 offen offset:1024 sc1
    v_mfma_f32_16x16x32_bf16 v[194:197], v[30:33], v[64:67], v[194:197]
    ds_read_b128 v[174:177], v51 offset:19456
    v_mfma_f32_16x16x32_bf16 v[198:201], v[34:37], v[64:67], v[198:201]
    ds_read_b128 v[178:181], v51 offset:20480
    v_mfma_f32_16x16x32_bf16 v[202:205], v[142:145], v[64:67], v[202:205]
    ds_read_b128 v[182:185], v51 offset:21504
    s_waitcnt lgkmcnt(5)
    v_mfma_f32_16x16x32_bf16 v[186:189], v[146:149], v[68:71], v[186:189]
    ds_read_b128 v[22:25], v51 offset:22528
    buffer_load_dwordx4 a[88:91], v8, s[12:15], s77 offen offset:2048 sc1
    v_mfma_f32_16x16x32_bf16 v[190:193], v[150:153], v[68:71], v[190:193]
    ds_read_b128 v[26:29], v51 offset:23552
    v_mfma_f32_16x16x32_bf16 v[194:197], v[154:157], v[68:71], v[194:197]
    ds_read_b128 v[30:33], v51 offset:24576
    v_mfma_f32_16x16x32_bf16 v[198:201], v[158:161], v[68:71], v[198:201]
    ds_read_b128 v[34:37], v51 offset:25600
    buffer_load_dwordx4 a[92:95], v8, s[12:15], s77 offen offset:3072 sc1
    v_mfma_f32_16x16x32_bf16 v[202:205], v[162:165], v[68:71], v[202:205]
    ds_read_b128 v[142:145], v51 offset:26624
    s_waitcnt lgkmcnt(5)
    v_mfma_f32_16x16x32_bf16 v[186:189], v[166:169], v[72:75], v[186:189]
    ds_read_b128 v[146:149], v51 offset:27648
    v_mfma_f32_16x16x32_bf16 v[190:193], v[170:173], v[72:75], v[190:193]
    ds_read_b128 v[150:153], v51 offset:28672
    s_add_u32 s77, s77, 4096
    buffer_load_dwordx4 a[96:99], v8, s[12:15], s77 offen offset:0 sc1
    v_mfma_f32_16x16x32_bf16 v[194:197], v[174:177], v[72:75], v[194:197]
    ds_read_b128 v[154:157], v51 offset:29696
    v_mfma_f32_16x16x32_bf16 v[198:201], v[178:181], v[72:75], v[198:201]
    ds_read_b128 v[158:161], v51 offset:30720
    v_mfma_f32_16x16x32_bf16 v[202:205], v[182:185], v[72:75], v[202:205]
    ds_read_b128 v[162:165], v51 offset:31744
    s_waitcnt vmcnt(37)
    s_barrier
    v_lshrrev_b32 v206, 3, v1
    v_mul_u32_u24 v206, 7168, v206
    v_and_b32 v207, 7, v1
    v_lshl_add_u32 v206, v207, 4, v206
    v_cmp_gt_u32 vcc, 5, v207
    v_mov_b32 v207, 0x40000000
    s_nop 0
    v_cndmask_b32 v13, v207, v206, vcc
    s_mul_i32 s56, s52, 229376
    s_add_u32 s56, s56, s73
    s_add_u32 s56, s56, 0x700000
    buffer_load_dwordx4 v[206:209], v13, s[12:15], s56 offen sc1
    s_add_u32 s56, s56, 57344
    buffer_load_dwordx4 v[210:213], v13, s[12:15], s56 offen sc1
    s_add_u32 s56, s56, 57344
    buffer_load_dwordx4 v[214:217], v13, s[12:15], s56 offen sc1
    s_add_u32 s56, s56, 57344
    buffer_load_dwordx4 v[218:221], v13, s[12:15], s56 offen sc1
    s_waitcnt lgkmcnt(5)
    v_mfma_f32_16x16x32_bf16 v[186:189], v[22:25], v[76:79], v[186:189]
    ds_read_b128 v[166:169], v50 offset:16384
    buffer_load_dwordx4 a[100:103], v8, s[12:15], s78 offen offset:0 sc1
    v_mfma_f32_16x16x32_bf16 v[190:193], v[26:29], v[76:79], v[190:193]
    ds_read_b128 v[170:173], v50 offset:17408
    v_mfma_f32_16x16x32_bf16 v[194:197], v[30:33], v[76:79], v[194:197]
    ds_read_b128 v[174:177], v50 offset:18432
    buffer_load_dwordx4 a[104:107], v8, s[12:15], s78 offen offset:1024 sc1
    v_mfma_f32_16x16x32_bf16 v[198:201], v[34:37], v[76:79], v[198:201]
    ds_read_b128 v[178:181], v50 offset:19456
    v_mfma_f32_16x16x32_bf16 v[202:205], v[142:145], v[76:79], v[202:205]
    ds_read_b128 v[182:185], v50 offset:20480
    s_waitcnt lgkmcnt(5)
    v_mfma_f32_16x16x32_bf16 v[186:189], v[146:149], v[80:83], v[186:189]
    ds_read_b128 v[22:25], v50 offset:21504
    buffer_load_dwordx4 a[108:111], v8, s[12:15], s78 offen offset:2048 sc1
    v_mfma_f32_16x16x32_bf16 v[190:193], v[150:153], v[80:83], v[190:193]
    ds_read_b128 v[26:29], v50 offset:22528
    v_mfma_f32_16x16x32_bf16 v[194:197], v[154:157], v[80:83], v[194:197]
    ds_read_b128 v[30:33], v50 offset:23552
    v_mfma_f32_16x16x32_bf16 v[198:201], v[158:161], v[80:83], v[198:201]
    ds_read_b128 v[34:37], v50 offset:24576
    buffer_load_dwordx4 a[112:115], v8, s[12:15], s78 offen offset:3072 sc1
    v_mfma_f32_16x16x32_bf16 v[202:205], v[162:165], v[80:83], v[202:205]
    ds_read_b128 v[142:145], v50 offset:25600
    s_waitcnt lgkmcnt(5)
    v_mfma_f32_16x16x32_bf16 v[186:189], v[166:169], v[84:87], v[186:189]
    ds_read_b128 v[146:149], v50 offset:26624
    s_add_u32 s78, s78, 4096
    buffer_load_dwordx4 a[116:119], v8, s[12:15], s78 offen offset:0 sc1
    v_mfma_f32_16x16x32_bf16 v[190:193], v[170:173], v[84:87], v[190:193]
    ds_read_b128 v[150:153], v50 offset:27648
    v_mfma_f32_16x16x32_bf16 v[194:197], v[174:177], v[84:87], v[194:197]
    ds_read_b128 v[154:157], v50 offset:28672
    buffer_load_dwordx4 a[120:123], v8, s[12:15], s78 offen offset:1024 sc1
    v_mfma_f32_16x16x32_bf16 v[198:201], v[178:181], v[84:87], v[198:201]
    ds_read_b128 v[158:161], v50 offset:29696
    v_mfma_f32_16x16x32_bf16 v[202:205], v[182:185], v[84:87], v[202:205]
    ds_read_b128 v[162:165], v50 offset:30720
    s_waitcnt lgkmcnt(5)
    v_mfma_f32_16x16x32_bf16 v[186:189], v[22:25], v[88:91], v[186:189]
    ds_read_b128 v[166:169], v50 offset:31744
    buffer_load_dwordx4 a[124:127], v8, s[12:15], s78 offen offset:2048 sc1
    v_mfma_f32_16x16x32_bf16 v[190:193], v[26:29], v[88:91], v[190:193]
    ds_read_b128 v[170:173], v50 offset:32768
    v_mfma_f32_16x16x32_bf16 v[194:197], v[30:33], v[88:91], v[194:197]
    ds_read_b128 v[174:177], v50 offset:33792
    v_mfma_f32_16x16x32_bf16 v[198:201], v[34:37], v[88:91], v[198:201]
    ds_read_b128 v[178:181], v50 offset:34816
    buffer_load_dwordx4 a[128:131], v8, s[12:15], s78 offen offset:3072 sc1
    v_mfma_f32_16x16x32_bf16 v[202:205], v[142:145], v[88:91], v[202:205]
    ds_read_b128 v[182:185], v50 offset:35840
    s_waitcnt vmcnt(44)
    s_barrier
    v_lshlrev_b32 v14, 3, v0
    v_mov_b32 v18, 0
    v_mov_b32 v19, 0
    v_add_u32 v14, 151552, v14
    ds_write_b64 v14, v[18:19]
    s_waitcnt lgkmcnt(6)
    v_mfma_f32_16x16x32_bf16 v[186:189], v[146:149], v[92:95], v[186:189]
    ds_read_b128 v[22:25], v50 offset:36864
    s_add_u32 s78, s78, 4096
    buffer_load_dwordx4 a[132:135], v8, s[12:15], s78 offen offset:0 sc1
    v_mfma_f32_16x16x32_bf16 v[190:193], v[150:153], v[92:95], v[190:193]
    ds_read_b128 v[26:29], v50 offset:37888
    v_mfma_f32_16x16x32_bf16 v[194:197], v[154:157], v[92:95], v[194:197]
    ds_read_b128 v[30:33], v50 offset:38912
    buffer_load_dwordx4 a[136:139], v8, s[12:15], s78 offen offset:1024 sc1
    v_mfma_f32_16x16x32_bf16 v[198:201], v[158:161], v[92:95], v[198:201]
    ds_read_b128 v[34:37], v50 offset:39936
    v_mfma_f32_16x16x32_bf16 v[202:205], v[162:165], v[92:95], v[202:205]
    ds_read_b128 v[142:145], v50 offset:40960
    buffer_load_dwordx4 a[140:143], v8, s[12:15], s78 offen offset:2048 sc1
    s_waitcnt lgkmcnt(6)
    v_mfma_f32_16x16x32_bf16 v[186:189], v[166:169], v[96:99], v[186:189]
    ds_read_b128 v[146:149], v50 offset:41984
    v_mfma_f32_16x16x32_bf16 v[190:193], v[170:173], v[96:99], v[190:193]
    ds_read_b128 v[150:153], v50 offset:43008
    v_mfma_f32_16x16x32_bf16 v[194:197], v[174:177], v[96:99], v[194:197]
    ds_read_b128 v[154:157], v50 offset:44032
    buffer_load_dwordx4 a[144:147], v8, s[12:15], s78 offen offset:3072 sc1
    v_mfma_f32_16x16x32_bf16 v[198:201], v[178:181], v[96:99], v[198:201]
    ds_read_b128 v[158:161], v50 offset:45056
    v_mfma_f32_16x16x32_bf16 v[202:205], v[182:185], v[96:99], v[202:205]
    ds_read_b128 v[162:165], v50 offset:46080
    s_add_u32 s78, s78, 4096
    buffer_load_dwordx4 a[148:151], v8, s[12:15], s78 offen offset:0 sc1
    s_waitcnt lgkmcnt(5)
    v_mfma_f32_16x16x32_bf16 v[186:189], v[22:25], v[100:103], v[186:189]
    ds_read_b128 v[166:169], v50 offset:47104
    v_mfma_f32_16x16x32_bf16 v[190:193], v[26:29], v[100:103], v[190:193]
    ds_read_b128 v[170:173], v50 offset:48128
    v_mfma_f32_16x16x32_bf16 v[194:197], v[30:33], v[100:103], v[194:197]
    ds_read_b128 v[174:177], v50 offset:49152
    buffer_load_dwordx4 a[152:155], v8, s[12:15], s78 offen offset:1024 sc1
    v_mfma_f32_16x16x32_bf16 v[198:201], v[34:37], v[100:103], v[198:201]
    ds_read_b128 v[178:181], v50 offset:50176
    v_mfma_f32_16x16x32_bf16 v[202:205], v[142:145], v[100:103], v[202:205]
    ds_read_b128 v[182:185], v50 offset:51200
    buffer_load_dwordx4 a[156:159], v8, s[12:15], s78 offen offset:2048 sc1
    s_waitcnt lgkmcnt(5)
    v_mfma_f32_16x16x32_bf16 v[186:189], v[146:149], v[104:107], v[186:189]
    ds_read_b128 v[22:25], v50 offset:52224
    v_mfma_f32_16x16x32_bf16 v[190:193], v[150:153], v[104:107], v[190:193]
    ds_read_b128 v[26:29], v50 offset:53248
    v_mfma_f32_16x16x32_bf16 v[194:197], v[154:157], v[104:107], v[194:197]
    ds_read_b128 v[30:33], v50 offset:54272
    buffer_load_dwordx4 a[160:163], v8, s[12:15], s78 offen offset:3072 sc1
    v_mfma_f32_16x16x32_bf16 v[198:201], v[158:161], v[104:107], v[198:201]
    ds_read_b128 v[34:37], v50 offset:55296
    v_mfma_f32_16x16x32_bf16 v[202:205], v[162:165], v[104:107], v[202:205]
    ds_read_b128 v[142:145], v50 offset:56320
    s_add_u32 s78, s78, 4096
    buffer_load_dwordx4 a[164:167], v8, s[12:15], s78 offen offset:0 sc1
    s_waitcnt vmcnt(31)
    s_barrier
    s_waitcnt lgkmcnt(5)
    v_mfma_f32_16x16x32_bf16 v[186:189], v[166:169], v[108:111], v[186:189]
    ds_read_b128 v[146:149], v49 offset:0
    v_mfma_f32_16x16x32_bf16 v[190:193], v[170:173], v[108:111], v[190:193]
    ds_read_b128 v[150:153], v49 offset:1024
    v_mfma_f32_16x16x32_bf16 v[194:197], v[174:177], v[108:111], v[194:197]
    ds_read_b128 v[154:157], v49 offset:2048
    buffer_load_dwordx4 a[168:171], v8, s[12:15], s78 offen offset:1024 sc1
    v_mfma_f32_16x16x32_bf16 v[198:201], v[178:181], v[108:111], v[198:201]
    ds_read_b128 v[158:161], v49 offset:3072
    v_mfma_f32_16x16x32_bf16 v[202:205], v[182:185], v[108:111], v[202:205]
    ds_read_b128 v[162:165], v49 offset:4096
    buffer_load_dwordx4 a[172:175], v8, s[12:15], s78 offen offset:2048 sc1
    s_waitcnt lgkmcnt(5)
    v_mfma_f32_16x16x32_bf16 v[186:189], v[22:25], v[112:115], v[186:189]
    ds_read_b128 v[166:169], v49 offset:5120
    v_mfma_f32_16x16x32_bf16 v[190:193], v[26:29], v[112:115], v[190:193]
    ds_read_b128 v[170:173], v49 offset:6144
    v_mfma_f32_16x16x32_bf16 v[194:197], v[30:33], v[112:115], v[194:197]
    ds_read_b128 v[174:177], v49 offset:7168
    buffer_load_dwordx4 a[176:179], v8, s[12:15], s78 offen offset:3072 sc1
    v_mfma_f32_16x16x32_bf16 v[198:201], v[34:37], v[112:115], v[198:201]
    ds_read_b128 v[178:181], v49 offset:8192
    v_mfma_f32_16x16x32_bf16 v[202:205], v[142:145], v[112:115], v[202:205]
    ds_read_b128 v[182:185], v49 offset:9216
    s_waitcnt lgkmcnt(5)
    v_mfma_f32_16x16x32_bf16 v[186:189], v[146:149], v[116:119], v[186:189]
    ds_read_b128 v[22:25], v49 offset:10240
    v_mfma_f32_16x16x32_bf16 v[190:193], v[150:153], v[116:119], v[190:193]
    ds_read_b128 v[26:29], v49 offset:11264
    v_mfma_f32_16x16x32_bf16 v[194:197], v[154:157], v[116:119], v[194:197]
    ds_read_b128 v[30:33], v49 offset:12288
    v_mfma_f32_16x16x32_bf16 v[198:201], v[158:161], v[116:119], v[198:201]
    ds_read_b128 v[34:37], v49 offset:13312
    v_mfma_f32_16x16x32_bf16 v[202:205], v[162:165], v[116:119], v[202:205]
    ds_read_b128 v[142:145], v49 offset:14336
    s_waitcnt lgkmcnt(5)
    v_mfma_f32_16x16x32_bf16 v[186:189], v[166:169], v[120:123], v[186:189]
    ds_read_b128 v[146:149], v49 offset:15360
    v_mfma_f32_16x16x32_bf16 v[190:193], v[170:173], v[120:123], v[190:193]
    ds_read_b128 v[150:153], v49 offset:16384
    v_mfma_f32_16x16x32_bf16 v[194:197], v[174:177], v[120:123], v[194:197]
    ds_read_b128 v[154:157], v49 offset:17408
    v_mfma_f32_16x16x32_bf16 v[198:201], v[178:181], v[120:123], v[198:201]
    ds_read_b128 v[158:161], v49 offset:18432
    v_mfma_f32_16x16x32_bf16 v[202:205], v[182:185], v[120:123], v[202:205]
    ds_read_b128 v[162:165], v49 offset:19456
    s_waitcnt lgkmcnt(5)
    v_mfma_f32_16x16x32_bf16 v[186:189], v[22:25], v[124:127], v[186:189]
    v_mfma_f32_16x16x32_bf16 v[190:193], v[26:29], v[124:127], v[190:193]
    v_mfma_f32_16x16x32_bf16 v[194:197], v[30:33], v[124:127], v[194:197]
    v_mfma_f32_16x16x32_bf16 v[198:201], v[34:37], v[124:127], v[198:201]
    v_mfma_f32_16x16x32_bf16 v[202:205], v[142:145], v[124:127], v[202:205]
    s_waitcnt lgkmcnt(0)
    v_mfma_f32_16x16x32_bf16 v[186:189], v[146:149], v[128:131], v[186:189]
    v_mfma_f32_16x16x32_bf16 v[190:193], v[150:153], v[128:131], v[190:193]
    v_mfma_f32_16x16x32_bf16 v[194:197], v[154:157], v[128:131], v[194:197]
    v_mfma_f32_16x16x32_bf16 v[198:201], v[158:161], v[128:131], v[198:201]
    v_mfma_f32_16x16x32_bf16 v[202:205], v[162:165], v[128:131], v[202:205]
    s_waitcnt vmcnt(20)
    s_mov_b32 s55, 0
L_chk_9:
    v_max3_u32 v18, v206, v207, v208
    v_max3_u32 v18, v18, v209, v210
    v_max3_u32 v18, v18, v211, v212
    v_max3_u32 v18, v18, v213, v214
    v_max3_u32 v18, v18, v215, v216
    v_max3_u32 v18, v18, v217, v218
    v_max3_u32 v18, v18, v219, v220
    v_max_u32 v18, v18, v221
    v_cmp_eq_u32 vcc, -1, v18
    s_cbranch_vccz L_ok_10
    s_add_u32 s55, s55, 1
    s_cmp_gt_u32 s55, 262144
    s_cbranch_scc1 L_ok_10
    s_sleep 8
    s_mul_i32 s56, s52, 229376
    s_add_u32 s56, s56, s73
    s_add_u32 s56, s56, 0x700000
    buffer_load_dwordx4 v[206:209], v13, s[12:15], s56 offen sc1
    s_add_u32 s56, s56, 57344
    buffer_load_dwordx4 v[210:213], v13, s[12:15], s56 offen sc1
    s_add_u32 s56, s56, 57344
    buffer_load_dwordx4 v[214:217], v13, s[12:15], s56 offen sc1
    s_add_u32 s56, s56, 57344
    buffer_load_dwordx4 v[218:221], v13, s[12:15], s56 offen sc1
    s_waitcnt vmcnt(0)
    s_branch L_chk_9
L_ok_10:
    v_lshlrev_b32 v38, 16, v206
    v_and_b32 v39, 0xffff0000, v206
    v_lshlrev_b32 v40, 16, v207
    v_and_b32 v41, 0xffff0000, v207
    v_lshlrev_b32 v42, 16, v208
    v_and_b32 v43, 0xffff0000, v208
    v_lshlrev_b32 v44, 16, v209
    v_and_b32 v45, 0xffff0000, v209
    v_lshlrev_b32 v18, 16, v210
    v_and_b32 v19, 0xffff0000, v210
    v_pk_add_f32 v[38:39], v[38:39], v[18:19]
    v_lshlrev_b32 v20, 16, v211
    v_and_b32 v21, 0xffff0000, v211
    v_pk_add_f32 v[40:41], v[40:41], v[20:21]
    v_lshlrev_b32 v18, 16, v212
    v_and_b32 v19, 0xffff0000, v212
    v_pk_add_f32 v[42:43], v[42:43], v[18:19]
    v_lshlrev_b32 v20, 16, v213
    v_and_b32 v21, 0xffff0000, v213
    v_pk_add_f32 v[44:45], v[44:45], v[20:21]
    v_lshlrev_b32 v18, 16, v214
    v_and_b32 v19, 0xffff0000, v214
    v_pk_add_f32 v[38:39], v[38:39], v[18:19]
    v_lshlrev_b32 v20, 16, v215
    v_and_b32 v21, 0xffff0000, v215
    v_pk_add_f32 v[40:41], v[40:41], v[20:21]
    v_lshlrev_b32 v18, 16, v216
    v_and_b32 v19, 0xffff0000, v216
    v_pk_add_f32 v[42:43], v[42:43], v[18:19]
    v_lshlrev_b32 v20, 16, v217
    v_and_b32 v21, 0xffff0000, v217
    v_pk_add_f32 v[44:45], v[44:45], v[20:21]
    v_lshlrev_b32 v18, 16, v218
    v_and_b32 v19, 0xffff0000, v218
    v_pk_add_f32 v[38:39], v[38:39], v[18:19]
    v_lshlrev_b32 v20, 16, v219
    v_and_b32 v21, 0xffff0000, v219
    v_pk_add_f32 v[40:41], v[40:41], v[20:21]
    v_lshlrev_b32 v18, 16, v220
    v_and_b32 v19, 0xffff0000, v220
    v_pk_add_f32 v[42:43], v[42:43], v[18:19]
    v_lshlrev_b32 v20, 16, v221
    v_and_b32 v21, 0xffff0000, v221
    v_pk_add_f32 v[44:45], v[44:45], v[20:21]
    v_add_f32_dpp v206, v38, v38 row_ror:8 row_mask:0xf bank_mask:0xf
    v_add_f32_dpp v207, v39, v39 row_ror:8 row_mask:0xf bank_mask:0xf
    v_add_f32_dpp v208, v40, v40 row_ror:8 row_mask:0xf bank_mask:0xf
    v_add_f32_dpp v209, v41, v41 row_ror:8 row_mask:0xf bank_mask:0xf
    v_add_f32_dpp v210, v42, v42 row_ror:8 row_mask:0xf bank_mask:0xf
    v_add_f32_dpp v211, v43, v43 row_ror:8 row_mask:0xf bank_mask:0xf
    v_add_f32_dpp v212, v44, v44 row_ror:8 row_mask:0xf bank_mask:0xf
    v_add_f32_dpp v213, v45, v45 row_ror:8 row_mask:0xf bank_mask:0xf
    v_permlane32_swap_b32 v206, v207
    v_add_f32 v206, v206, v207
    v_mov_b32 v14, v206
    s_nop 1
    v_permlane16_swap_b32 v206, v14
    v_add_f32 v206, v206, v14
    v_mov_b32 v207, v206
    s_nop 1
    v_permlane32_swap_b32 v206, v207
    v_permlane32_swap_b32 v208, v209
    v_add_f32 v208, v208, v209
    v_mov_b32 v14, v208
    s_nop 1
    v_permlane16_swap_b32 v208, v14
    v_add_f32 v208, v208, v14
    v_mov_b32 v209, v208
    s_nop 1
    v_permlane32_swap_b32 v208, v209
    v_permlane32_swap_b32 v210, v211
    v_add_f32 v210, v210, v211
    v_mov_b32 v14, v210
    s_nop 1
    v_permlane16_swap_b32 v210, v14
    v_add_f32 v210, v210, v14
    v_mov_b32 v211, v210
    s_nop 1
    v_permlane32_swap_b32 v210, v211
    v_permlane32_swap_b32 v212, v213
    v_add_f32 v212, v212, v213
    v_mov_b32 v14, v212
    s_nop 1
    v_permlane16_swap_b32 v212, v14
    v_add_f32 v212, v212, v14
    v_mov_b32 v213, v212
    s_nop 1
    v_permlane32_swap_b32 v212, v213
    v_cvt_pk_bf16_f32 v18, v206, v207
    v_cvt_pk_bf16_f32 v19, v208, v209
    v_cvt_pk_bf16_f32 v20, v210, v211
    v_cvt_pk_bf16_f32 v21, v212, v213
    buffer_store_dwordx4 v[18:21], v16, s[12:15], s74 offen sc1
    v_mul_u32_u24 v14, 800, v2
    v_mad_u32_u24 v14, v4, 40, v14
    v_add_u32 v14, 77824, v14
    v_cmp_eq_u32 vcc, v2, v5
    v_mov_b32 v13, 75776
    s_nop 0
    v_cndmask_b32 v13, v13, v14, vcc
    ds_read_b64_tr_b16 v[16:17], v13 offset:0
    ds_read_b64_tr_b16 v[18:19], v13 offset:160
    ds_read_b64_tr_b16 v[38:39], v13 offset:8
    ds_read_b64_tr_b16 v[40:41], v13 offset:168
    ds_read_b64_tr_b16 v[42:43], v13 offset:16
    ds_read_b64_tr_b16 v[44:45], v13 offset:176
    ds_read_b64_tr_b16 v[46:47], v13 offset:24
    ds_read_b64_tr_b16 v[48:49], v13 offset:184
    ds_read_b64_tr_b16 v[50:51], v13 offset:32
    ds_read_b64_tr_b16 v[52:53], v13 offset:192
    ds_read_b64_tr_b16 v[54:55], v13 offset:320
    ds_read_b64_tr_b16 v[56:57], v13 offset:480
    ds_read_b64_tr_b16 v[58:59], v13 offset:328
    ds_read_b64_tr_b16 v[60:61], v13 offset:488
    ds_read_b64_tr_b16 v[62:63], v13 offset:336
    ds_read_b64_tr_b16 v[64:65], v13 offset:496
    ds_read_b64_tr_b16 v[66:67], v13 offset:344
    ds_read_b64_tr_b16 v[68:69], v13 offset:504
    ds_read_b64_tr_b16 v[70:71], v13 offset:352
    ds_read_b64_tr_b16 v[72:73], v13 offset:512
    ds_read_b64_tr_b16 v[74:75], v13 offset:640
    v_mov_b32 v76, 0
    v_mov_b32 v77, 0
    ds_read_b64_tr_b16 v[78:79], v13 offset:648
    v_mov_b32 v80, 0
    v_mov_b32 v81, 0
    ds_read_b64_tr_b16 v[82:83], v13 offset:656
    v_mov_b32 v84, 0
    v_mov_b32 v85, 0
    ds_read_b64_tr_b16 v[86:87], v13 offset:664
    v_mov_b32 v88, 0
    v_mov_b32 v89, 0
    ds_read_b64_tr_b16 v[90:91], v13 offset:672
    v_mov_b32 v92, 0
    v_mov_b32 v93, 0
    v_mov_b32 v176, 0
    v_mov_b32 v177, 0
    s_add_u32 s78, s78, 4096
    buffer_load_dwordx4 a[180:183], v8, s[12:15], s78 offen offset:0 sc1
    v_cvt_pk_bf16_f32 v166, v186, v187
    v_cvt_pk_bf16_f32 v167, v188, v189
    v_cvt_pk_bf16_f32 v168, v190, v191
    v_cvt_pk_bf16_f32 v169, v192, v193
    v_cvt_pk_bf16_f32 v170, v194, v195
    v_cvt_pk_bf16_f32 v171, v196, v197
    v_cvt_pk_bf16_f32 v172, v198, v199
    v_cvt_pk_bf16_f32 v173, v200, v201
    v_cvt_pk_bf16_f32 v174, v202, v203
    v_cvt_pk_bf16_f32 v175, v204, v205
    s_waitcnt lgkmcnt(15)
    v_mfma_f32_16x16x32_bf16 v[186:189], v[16:19], v[166:169], 0
    s_waitcnt lgkmcnt(15)
    v_mfma_f32_16x16x32_bf16 v[190:193], v[38:41], v[166:169], 0
    buffer_load_dwordx4 a[184:187], v8, s[12:15], s78 offen offset:1024 sc1
    s_waitcnt lgkmcnt(15)
    v_mfma_f32_16x16x32_bf16 v[194:197], v[42:45], v[166:169], 0
    s_waitcnt lgkmcnt(15)
    v_mfma_f32_16x16x32_bf16 v[198:201], v[46:49], v[166:169], 0
    s_waitcnt lgkmcnt(15)
    v_mfma_f32_16x16x32_bf16 v[202:205], v[50:53], v[166:169], 0
    s_waitcnt lgkmcnt(13)
    v_mfma_f32_16x16x32_bf16 v[186:189], v[54:57], v[170:173], v[186:189]
    buffer_load_dwordx4 a[188:191], v8, s[12:15], s78 offen offset:2048 sc1
    s_waitcnt lgkmcnt(11)
    v_mfma_f32_16x16x32_bf16 v[190:193], v[58:61], v[170:173], v[190:193]
    s_waitcnt lgkmcnt(9)
    v_mfma_f32_16x16x32_bf16 v[194:197], v[62:65], v[170:173], v[194:197]
    s_waitcnt lgkmcnt(7)
    v_mfma_f32_16x16x32_bf16 v[198:201], v[66:69], v[170:173], v[198:201]
    s_waitcnt lgkmcnt(5)
    v_mfma_f32_16x16x32_bf16 v[202:205], v[70:73], v[170:173], v[202:205]
    buffer_load_dwordx4 a[192:195], v8, s[12:15], s78 offen offset:3072 sc1
    s_waitcnt lgkmcnt(4)
    v_mfma_f32_16x16x32_bf16 v[186:189], v[74:77], v[174:177], v[186:189]
    s_waitcnt lgkmcnt(3)
    v_mfma_f32_16x16x32_bf16 v[190:193], v[78:81], v[174:177], v[190:193]
    s_waitcnt lgkmcnt(2)
    v_mfma_f32_16x16x32_bf16 v[194:197], v[82:85], v[174:177], v[194:197]
    s_waitcnt lgkmcnt(1)
    v_mfma_f32_16x16x32_bf16 v[198:201], v[86:89], v[174:177], v[198:201]
    s_add_u32 s78, s78, 4096
    buffer_load_dwordx4 a[196:199], v8, s[12:15], s78 offen offset:0 sc1
    s_waitcnt lgkmcnt(0)
    v_mfma_f32_16x16x32_bf16 v[202:205], v[90:93], v[174:177], v[202:205]
    v_max3_f32 v20, v186, v187, v188
    v_min3_f32 v21, v186, v187, v188
    v_max3_f32 v20, v20, v189, v190
    v_min3_f32 v21, v21, v189, v190
    v_max3_f32 v20, v20, v191, v192
    v_min3_f32 v21, v21, v191, v192
    v_max3_f32 v20, v20, v193, v194
    v_min3_f32 v21, v21, v193, v194
    v_max3_f32 v20, v20, v195, v196
    v_min3_f32 v21, v21, v195, v196
    v_max3_f32 v20, v20, v197, v198
    v_min3_f32 v21, v21, v197, v198
    v_max3_f32 v20, v20, v199, v200
    v_min3_f32 v21, v21, v199, v200
    v_max3_f32 v20, v20, v201, v202
    v_min3_f32 v21, v21, v201, v202
    v_max3_f32 v20, v20, v203, v204
    v_min3_f32 v21, v21, v203, v204
    v_max_f32 v20, v20, v205
    v_min_f32 v21, v21, v205
    v_pk_mul_f32 v[20:21], v[20:21], s[68:69]
    v_pk_fma_f32 v[22:23], v[186:187], s[68:69], v[20:21] op_sel_hi:[1,1,0] neg_lo:[0,0,1] neg_hi:[0,0,1]
    v_pk_fma_f32 v[146:147], v[186:187], s[68:69], v[20:21] op_sel:[0,0,1] op_sel_hi:[1,1,1] neg_lo:[1,0,0] neg_hi:[1,0,0]
    buffer_load_dwordx4 a[200:203], v8, s[12:15], s78 offen offset:1024 sc1
    v_pk_fma_f32 v[24:25], v[188:189], s[68:69], v[20:21] op_sel_hi:[1,1,0] neg_lo:[0,0,1] neg_hi:[0,0,1]
    v_pk_fma_f32 v[148:149], v[188:189], s[68:69], v[20:21] op_sel:[0,0,1] op_sel_hi:[1,1,1] neg_lo:[1,0,0] neg_hi:[1,0,0]
    buffer_load_dwordx4 a[204:207], v8, s[12:15], s78 offen offset:2048 sc1
    v_pk_fma_f32 v[26:27], v[190:191], s[68:69], v[20:21] op_sel_hi:[1,1,0] neg_lo:[0,0,1] neg_hi:[0,0,1]
    v_pk_fma_f32 v[150:151], v[190:191], s[68:69], v[20:21] op_sel:[0,0,1] op_sel_hi:[1,1,1] neg_lo:[1,0,0] neg_hi:[1,0,0]
    v_pk_fma_f32 v[28:29], v[192:193], s[68:69], v[20:21] op_sel_hi:[1,1,0] neg_lo:[0,0,1] neg_hi:[0,0,1]
    v_pk_fma_f32 v[152:153], v[192:193], s[68:69], v[20:21] op_sel:[0,0,1] op_sel_hi:[1,1,1] neg_lo:[1,0,0] neg_hi:[1,0,0]
    v_pk_fma_f32 v[30:31], v[194:195], s[68:69], v[20:21] op_sel_hi:[1,1,0] neg_lo:[0,0,1] neg_hi:[0,0,1]
    v_pk_fma_f32 v[154:155], v[194:195], s[68:69], v[20:21] op_sel:[0,0,1] op_sel_hi:[1,1,1] neg_lo:[1,0,0] neg_hi:[1,0,0]
    v_pk_fma_f32 v[32:33], v[196:197], s[68:69], v[20:21] op_sel_hi:[1,1,0] neg_lo:[0,0,1] neg_hi:[0,0,1]
    v_pk_fma_f32 v[156:157], v[196:197], s[68:69], v[20:21] op_sel:[0,0,1] op_sel_hi:[1,1,1] neg_lo:[1,0,0] neg_hi:[1,0,0]
    v_pk_fma_f32 v[34:35], v[198:199], s[68:69], v[20:21] op_sel_hi:[1,1,0] neg_lo:[0,0,1] neg_hi:[0,0,1]
    v_pk_fma_f32 v[158:159], v[198:199], s[68:69], v[20:21] op_sel:[0,0,1] op_sel_hi:[1,1,1] neg_lo:[1,0,0] neg_hi:[1,0,0]
    v_pk_fma_f32 v[36:37], v[200:201], s[68:69], v[20:21] op_sel_hi:[1,1,0] neg_lo:[0,0,1] neg_hi:[0,0,1]
    v_pk_fma_f32 v[160:161], v[200:201], s[68:69], v[20:21] op_sel:[0,0,1] op_sel_hi:[1,1,1] neg_lo:[1,0,0] neg_hi:[1,0,0]
    v_pk_fma_f32 v[142:143], v[202:203], s[68:69], v[20:21] op_sel_hi:[1,1,0] neg_lo:[0,0,1] neg_hi:[0,0,1]
    v_pk_fma_f32 v[162:163], v[202:203], s[68:69], v[20:21] op_sel:[0,0,1] op_sel_hi:[1,1,1] neg_lo:[1,0,0] neg_hi:[1,0,0]
    v_pk_fma_f32 v[144:145], v[204:205], s[68:69], v[20:21] op_sel_hi:[1,1,0] neg_lo:[0,0,1] neg_hi:[0,0,1]
    v_pk_fma_f32 v[164:165], v[204:205], s[68:69], v[20:21] op_sel:[0,0,1] op_sel_hi:[1,1,1] neg_lo:[1,0,0] neg_hi:[1,0,0]
    buffer_load_dwordx4 a[208:211], v8, s[12:15], s78 offen offset:3072 sc1
    v_exp_f32 v22, v22
    v_exp_f32 v23, v23
    v_exp_f32 v24, v24
    v_exp_f32 v25, v25
    v_exp_f32 v26, v26
    v_exp_f32 v27, v27
    v_exp_f32 v28, v28
    s_add_u32 s78, s78, 4096
    buffer_load_dwordx4 a[212:215], v8, s[12:15], s78 offen offset:0 sc1
    v_exp_f32 v29, v29
    v_exp_f32 v30, v30
    v_exp_f32 v31, v31
    v_exp_f32 v32, v32
    v_exp_f32 v33, v33
    v_exp_f32 v34, v34
    v_exp_f32 v35, v35
    v_exp_f32 v36, v36
    buffer_load_dwordx4 a[216:219], v8, s[12:15], s78 offen offset:1024 sc1
    v_exp_f32 v37, v37
    v_exp_f32 v142, v142
    v_exp_f32 v143, v143
    v_exp_f32 v144, v144
    v_exp_f32 v145, v145
    v_exp_f32 v146, v146
    v_exp_f32 v147, v147
    buffer_load_dwordx4 a[220:223], v8, s[12:15], s78 offen offset:2048 sc1
    v_exp_f32 v148, v148
    v_exp_f32 v149, v149
    v_exp_f32 v150, v150
    v_exp_f32 v151, v151
    v_exp_f32 v152, v152
    v_exp_f32 v153, v153
    v_exp_f32 v154, v154
    v_exp_f32 v155, v155
    buffer_load_dwordx4 a[224:227], v8, s[12:15], s78 offen offset:3072 sc1
    v_exp_f32 v156, v156
    v_exp_f32 v157, v157
    v_exp_f32 v158, v158
    v_exp_f32 v159, v159
    v_exp_f32 v160, v160
    v_exp_f32 v161, v161
    v_exp_f32 v162, v162
    v_exp_f32 v163, v163
    v_exp_f32 v164, v164
    v_exp_f32 v165, v165
    s_mul_i32 s56, s61, 1792
    s_add_u32 s56, s56, 0xc00000
    buffer_load_dwordx4 v[118:121], v8, s[12:15], s56 offen sc1
    buffer_load_dwordx4 v[122:125], v15, s[12:15], s56 offen offset:1024 sc1
    v_pk_add_f32 v[126:127], v[22:23], v[24:25]
    v_pk_add_f32 v[126:127], v[126:127], v[26:27]
    v_pk_add_f32 v[126:127], v[126:127], v[28:29]
    v_pk_add_f32 v[126:127], v[126:127], v[30:31]
    v_pk_add_f32 v[126:127], v[126:127], v[32:33]
    v_pk_add_f32 v[126:127], v[126:127], v[34:35]
    v_pk_add_f32 v[126:127], v[126:127], v[36:37]
    v_pk_add_f32 v[126:127], v[126:127], v[142:143]
    v_pk_add_f32 v[126:127], v[126:127], v[144:145]
    v_pk_add_f32 v[128:129], v[146:147], v[148:149]
    v_pk_add_f32 v[128:129], v[128:129], v[150:151]
    v_pk_add_f32 v[128:129], v[128:129], v[152:153]
    v_pk_add_f32 v[128:129], v[128:129], v[154:155]
    v_pk_add_f32 v[128:129], v[128:129], v[156:157]
    v_pk_add_f32 v[128:129], v[128:129], v[158:159]
    v_pk_add_f32 v[128:129], v[128:129], v[160:161]
    v_pk_add_f32 v[128:129], v[128:129], v[162:163]
    v_pk_add_f32 v[128:129], v[128:129], v[164:165]
    v_add_f32 v20, v126, v127
    v_add_f32 v21, v128, v129
    v_rcp_f32 v20, v20
    v_rcp_f32 v21, v21
    s_nop 0
    v_pk_mul_f32 v[22:23], v[22:23], v[20:21] op_sel_hi:[1,0]
    s_add_u32 s78, s78, 4096
    buffer_load_dwordx4 a[228:231], v8, s[12:15], s78 offen offset:0 sc1
    v_pk_mul_f32 v[24:25], v[24:25], v[20:21] op_sel_hi:[1,0]
    buffer_load_dwordx4 a[232:235], v8, s[12:15], s78 offen offset:1024 sc1
    v_pk_mul_f32 v[26:27], v[26:27], v[20:21] op_sel_hi:[1,0]
    buffer_load_dwordx4 a[236:239], v8, s[12:15], s78 offen offset:2048 sc1
    v_pk_mul_f32 v[28:29], v[28:29], v[20:21] op_sel_hi:[1,0]
    v_pk_mul_f32 v[30:31], v[30:31], v[20:21] op_sel_hi:[1,0]
    v_pk_mul_f32 v[32:33], v[32:33], v[20:21] op_sel_hi:[1,0]
    v_pk_mul_f32 v[34:35], v[34:35], v[20:21] op_sel_hi:[1,0]
    v_pk_mul_f32 v[36:37], v[36:37], v[20:21] op_sel_hi:[1,0]
    v_pk_mul_f32 v[142:143], v[142:143], v[20:21] op_sel_hi:[1,0]
    v_pk_mul_f32 v[144:145], v[144:145], v[20:21] op_sel_hi:[1,0]
    buffer_load_dwordx4 a[240:243], v8, s[12:15], s78 offen offset:3072 sc1
    v_pk_mul_f32 v[146:147], v[146:147], v[20:21] op_sel:[0,1] op_sel_hi:[1,1]
    v_pk_mul_f32 v[148:149], v[148:149], v[20:21] op_sel:[0,1] op_sel_hi:[1,1]
    v_pk_mul_f32 v[150:151], v[150:151], v[20:21] op_sel:[0,1] op_sel_hi:[1,1]
    v_pk_mul_f32 v[152:153], v[152:153], v[20:21] op_sel:[0,1] op_sel_hi:[1,1]
    v_pk_mul_f32 v[154:155], v[154:155], v[20:21] op_sel:[0,1] op_sel_hi:[1,1]
    v_pk_mul_f32 v[156:157], v[156:157], v[20:21] op_sel:[0,1] op_sel_hi:[1,1]
    v_pk_mul_f32 v[158:159], v[158:159], v[20:21] op_sel:[0,1] op_sel_hi:[1,1]
    v_pk_mul_f32 v[160:161], v[160:161], v[20:21] op_sel:[0,1] op_sel_hi:[1,1]
    v_pk_mul_f32 v[162:163], v[162:163], v[20:21] op_sel:[0,1] op_sel_hi:[1,1]
    v_pk_mul_f32 v[164:165], v[164:165], v[20:21] op_sel:[0,1] op_sel_hi:[1,1]
    v_cvt_pk_bf16_f32 v186, v22, v23
    s_add_u32 s78, s78, 4096
    buffer_load_dwordx4 a[244:247], v8, s[12:15], s78 offen offset:0 sc1
    v_cvt_pk_bf16_f32 v187, v24, v25
    v_cvt_pk_bf16_f32 v188, v26, v27
    v_cvt_pk_bf16_f32 v189, v28, v29
    v_cvt_pk_bf16_f32 v190, v30, v31
    v_cvt_pk_bf16_f32 v191, v32, v33
    v_cvt_pk_bf16_f32 v192, v34, v35
    v_cvt_pk_bf16_f32 v193, v36, v37
    v_cvt_pk_bf16_f32 v194, v142, v143
    v_cvt_pk_bf16_f32 v195, v144, v145
    v_cvt_pk_bf16_f32 v196, v146, v147
    v_cvt_pk_bf16_f32 v197, v148, v149
    v_cvt_pk_bf16_f32 v198, v150, v151
    v_cvt_pk_bf16_f32 v199, v152, v153
    v_cvt_pk_bf16_f32 v200, v154, v155
    v_cvt_pk_bf16_f32 v201, v156, v157
    v_cvt_pk_bf16_f32 v202, v158, v159
    v_cvt_pk_bf16_f32 v203, v160, v161
    v_cvt_pk_bf16_f32 v204, v162, v163
    v_cvt_pk_bf16_f32 v205, v164, v165
    v_mov_b32 v32, 0x3f803f80
    v_mov_b32 v33, 0x3f803f80
    v_mov_b32 v34, 0x3f803f80
    v_mov_b32 v35, 0x3f803f80
    s_waitcnt vmcnt(39)
    s_nop 0
    v_mfma_f32_16x16x32_bf16 v[20:23], a[100:103], v[32:35], 0
    s_waitcnt vmcnt(38)
    v_mfma_f32_16x16x32_bf16 v[24:27], a[104:107], v[32:35], 0
    s_waitcnt vmcnt(37)
    v_mfma_f32_16x16x32_bf16 v[28:31], a[108:111], v[32:35], 0
    s_waitcnt vmcnt(36)
    v_mfma_f32_16x16x32_bf16 v[20:23], a[112:115], v[32:35], v[20:23]
    s_waitcnt vmcnt(35)
    v_mfma_f32_16x16x32_bf16 v[24:27], a[116:119], v[32:35], v[24:27]
    s_waitcnt vmcnt(34)
    v_mfma_f32_16x16x32_bf16 v[28:31], a[120:123], v[32:35], v[28:31]
    s_waitcnt vmcnt(33)
    v_mfma_f32_16x16x32_bf16 v[20:23], a[124:127], v[32:35], v[20:23]
    s_waitcnt vmcnt(32)
    v_mfma_f32_16x16x32_bf16 v[24:27], a[128:131], v[32:35], v[24:27]
    s_waitcnt vmcnt(31)
    v_mfma_f32_16x16x32_bf16 v[28:31], a[132:135], v[32:35], v[28:31]
    s_waitcnt vmcnt(30)
    v_mfma_f32_16x16x32_bf16 v[20:23], a[136:139], v[32:35], v[20:23]
    s_waitcnt vmcnt(29)
    v_mfma_f32_16x16x32_bf16 v[24:27], a[140:143], v[32:35], v[24:27]
    s_waitcnt vmcnt(28)
    v_mfma_f32_16x16x32_bf16 v[28:31], a[144:147], v[32:35], v[28:31]
    s_lshl_b32 s56, s3, 11
    s_add_u32 s56, s56, 143360
    v_add_u32 v13, s56, v8
    v_mul_u32_u24 v14, 80, v5
    v_lshl_add_u32 v14, v2, 11, v14
    v_add_u32 v14, 143360, v14
    v_cmp_eq_u32 vcc, v2, v4
    v_mov_b32 v36, 151552
    s_nop 0
    v_cndmask_b32 v36, v36, v14, vcc
    s_waitcnt vmcnt(5)
    s_mov_b32 s55, 0
L_chk_11:
    v_max3_u32 v14, v118, v119, v120
    v_max3_u32 v14, v14, v121, v122
    v_max3_u32 v14, v14, v123, v124
    v_max_u32 v14, v14, v125
    v_cmp_eq_u32 vcc, -1, v14
    s_cbranch_vccz L_ok_12
    s_add_u32 s55, s55, 1
    s_cmp_gt_u32 s55, 262144
    s_cbranch_scc1 L_ok_12
    s_sleep 8
    s_mul_i32 s56, s61, 1792
    s_add_u32 s56, s56, 0xc00000
    buffer_load_dwordx4 v[118:121], v8, s[12:15], s56 offen sc1
    buffer_load_dwordx4 v[122:125], v15, s[12:15], s56 offen offset:1024 sc1
    s_waitcnt vmcnt(0)
    s_branch L_chk_11
L_ok_12:
    ds_write_b128 v13, v[118:121]
    ds_write_b128 v13, v[122:125] offset:1024
    s_waitcnt lgkmcnt(0)
    s_barrier
    s_mul_i32 s72, s61, 61440
    s_add_u32 s72, s72, 0x300000
    s_mul_i32 s73, s3, 19456
    ds_read_b128 v[126:129], v36 offset:1600
    ds_read_b128 v[142:145], v36 offset:0
    ds_read_b128 v[146:149], v36 offset:320
    ds_read_b128 v[150:153], v36 offset:640
    ds_read_b128 v[154:157], v36 offset:960
    ds_read_b128 v[158:161], v36 offset:1280
    ds_read_b128 v[162:165], v36 offset:1616
    ds_read_b128 v[166:169], v36 offset:16
    ds_read_b128 v[170:173], v36 offset:336
    ds_read_b128 v[174:177], v36 offset:656
    ds_read_b128 v[178:181], v36 offset:976
    ds_read_b128 v[182:185], v36 offset:1296
    s_waitcnt lgkmcnt(11)
    v_mfma_f32_16x16x32_bf16 v[242:245], v[126:129], v[186:189], 0
    ds_read_b128 v[206:209], v36 offset:1632
    buffer_load_dwordx4 a[248:251], v8, s[12:15], s78 offen offset:1024 sc1
    s_waitcnt lgkmcnt(11)
    v_mfma_f32_16x16x32_bf16 v[222:225], v[142:145], v[186:189], 0
    ds_read_b128 v[210:213], v36 offset:32
    buffer_load_dwordx4 a[252:255], v8, s[12:15], s78 offen offset:2048 sc1
    s_waitcnt lgkmcnt(11)
    v_mfma_f32_16x16x32_bf16 v[226:229], v[146:149], v[186:189], 0
    ds_read_b128 v[214:217], v36 offset:352
    s_waitcnt lgkmcnt(11)
    v_mfma_f32_16x16x32_bf16 v[230:233], v[150:153], v[186:189], 0
    ds_read_b128 v[218:221], v36 offset:672
    buffer_load_dwordx4 v[16:19], v8, s[12:15], s78 offen offset:3072 sc1
    s_waitcnt lgkmcnt(11)
    v_mfma_f32_16x16x32_bf16 v[234:237], v[154:157], v[186:189], 0
    ds_read_b128 v[126:129], v36 offset:992
    s_waitcnt lgkmcnt(11)
    v_mfma_f32_16x16x32_bf16 v[238:241], v[158:161], v[186:189], 0
    ds_read_b128 v[142:145], v36 offset:1312
    s_waitcnt lgkmcnt(11)
    v_mfma_f32_16x16x32_bf16 v[242:245], v[162:165], v[190:193], v[242:245]
    ds_read_b128 v[146:149], v36 offset:1648
    s_add_u32 s78, s78, 4096
    buffer_load_dwordx4 v[38:41], v8, s[12:15], s78 offen offset:0 sc1
    s_waitcnt lgkmcnt(11)
    v_mfma_f32_16x16x32_bf16 v[222:225], v[166:169], v[190:193], v[222:225]
    ds_read_b128 v[150:153], v36 offset:48
    s_waitcnt lgkmcnt(11)
    v_mfma_f32_16x16x32_bf16 v[226:229], v[170:173], v[190:193], v[226:229]
    ds_read_b128 v[154:157], v36 offset:368
    s_waitcnt lgkmcnt(11)
    v_mfma_f32_16x16x32_bf16 v[230:233], v[174:177], v[190:193], v[230:233]
    ds_read_b128 v[158:161], v36 offset:688
    buffer_load_dwordx4 v[42:45], v8, s[12:15], s78 offen offset:1024 sc1
    s_waitcnt lgkmcnt(11)
    v_mfma_f32_16x16x32_bf16 v[234:237], v[178:181], v[190:193], v[234:237]
    ds_read_b128 v[162:165], v36 offset:1008
    s_waitcnt lgkmcnt(11)
    v_mfma_f32_16x16x32_bf16 v[238:241], v[182:185], v[190:193], v[238:241]
    ds_read_b128 v[166:169], v36 offset:1328
    s_waitcnt lgkmcnt(11)
    v_mfma_f32_16x16x32_bf16 v[242:245], v[206:209], v[194:197], v[242:245]
    ds_read_b128 v[170:173], v36 offset:1664
    s_waitcnt lgkmcnt(11)
    v_mfma_f32_16x16x32_bf16 v[222:225], v[210:213], v[194:197], v[222:225]
    ds_read_b128 v[174:177], v36 offset:64
    buffer_load_dwordx4 v[46:49], v8, s[12:15], s78 offen offset:2048 sc1
    s_waitcnt lgkmcnt(11)
    v_mfma_f32_16x16x32_bf16 v[226:229], v[214:217], v[194:197], v[226:229]
    ds_read_b128 v[178:181], v36 offset:384
    s_waitcnt lgkmcnt(11)
    v_mfma_f32_16x16x32_bf16 v[230:233], v[218:221], v[194:197], v[230:233]
    ds_read_b128 v[182:185], v36 offset:704
    s_waitcnt lgkmcnt(11)
    v_mfma_f32_16x16x32_bf16 v[234:237], v[126:129], v[194:197], v[234:237]
    ds_read_b128 v[206:209], v36 offset:1024
    buffer_load_dwordx4 v[50:53], v8, s[12:15], s78 offen offset:3072 sc1
    s_waitcnt lgkmcnt(11)
    v_mfma_f32_16x16x32_bf16 v[238:241], v[142:145], v[194:197], v[238:241]
    ds_read_b128 v[210:213], v36 offset:1344
    s_waitcnt lgkmcnt(11)
    v_mfma_f32_16x16x32_bf16 v[242:245], v[146:149], v[198:201], v[242:245]
    s_waitcnt lgkmcnt(10)
    v_mfma_f32_16x16x32_bf16 v[222:225], v[150:153], v[198:201], v[222:225]
    s_add_u32 s78, s78, 4096
    buffer_load_dwordx4 v[54:57], v8, s[12:15], s78 offen offset:0 sc1
    s_waitcnt lgkmcnt(9)
    v_mfma_f32_16x16x32_bf16 v[226:229], v[154:157], v[198:201], v[226:229]
    s_waitcnt lgkmcnt(8)
    v_mfma_f32_16x16x32_bf16 v[230:233], v[158:161], v[198:201], v[230:233]
    s_waitcnt lgkmcnt(7)
    v_mfma_f32_16x16x32_bf16 v[234:237], v[162:165], v[198:201], v[234:237]
    s_waitcnt lgkmcnt(6)
    v_mfma_f32_16x16x32_bf16 v[238:241], v[166:169], v[198:201], v[238:241]
    buffer_load_dwordx4 v[58:61], v8, s[12:15], s78 offen offset:1024 sc1
    s_waitcnt lgkmcnt(5)
    v_mfma_f32_16x16x32_bf16 v[242:245], v[170:173], v[202:205], v[242:245]
    s_waitcnt lgkmcnt(4)
    v_mfma_f32_16x16x32_bf16 v[222:225], v[174:177], v[202:205], v[222:225]
    s_waitcnt lgkmcnt(3)
    v_mfma_f32_16x16x32_bf16 v[226:229], v[178:181], v[202:205], v[226:229]
    buffer_load_dwordx4 v[62:65], v8, s[12:15], s78 offen offset:2048 sc1
    s_waitcnt lgkmcnt(2)
    v_mfma_f32_16x16x32_bf16 v[230:233], v[182:185], v[202:205], v[230:233]
    s_waitcnt lgkmcnt(1)
    v_mfma_f32_16x16x32_bf16 v[234:237], v[206:209], v[202:205], v[234:237]
    s_waitcnt lgkmcnt(0)
    v_mfma_f32_16x16x32_bf16 v[238:241], v[210:213], v[202:205], v[238:241]
    v_add_f32 v242, 0x358637bd, v242
    v_rcp_f32 v242, v242
    s_nop 0
    v_pk_mul_f32 v[222:223], v[222:223], v[242:243] op_sel_hi:[1,0]
    v_pk_mul_f32 v[224:225], v[224:225], v[242:243] op_sel_hi:[1,0]
    v_pk_mul_f32 v[226:227], v[226:227], v[242:243] op_sel_hi:[1,0]
    v_pk_mul_f32 v[228:229], v[228:229], v[242:243] op_sel_hi:[1,0]
    v_pk_mul_f32 v[230:231], v[230:231], v[242:243] op_sel_hi:[1,0]
    v_pk_mul_f32 v[232:233], v[232:233], v[242:243] op_sel_hi:[1,0]
    v_pk_mul_f32 v[234:235], v[234:235], v[242:243] op_sel_hi:[1,0]
    v_pk_mul_f32 v[236:237], v[236:237], v[242:243] op_sel_hi:[1,0]
    v_pk_mul_f32 v[238:239], v[238:239], v[242:243] op_sel_hi:[1,0]
    v_pk_mul_f32 v[240:241], v[240:241], v[242:243] op_sel_hi:[1,0]
    v_cvt_pk_bf16_f32 v126, v222, v223
    v_cvt_pk_bf16_f32 v127, v224, v225
    v_cvt_pk_bf16_f32 v128, v226, v227
    v_cvt_pk_bf16_f32 v129, v228, v229
    v_cvt_pk_bf16_f32 v142, v230, v231
    v_cvt_pk_bf16_f32 v143, v232, v233
    v_cvt_pk_bf16_f32 v144, v234, v235
    v_cvt_pk_bf16_f32 v145, v236, v237
    v_cvt_pk_bf16_f32 v146, v238, v239
    v_cvt_pk_bf16_f32 v147, v240, v241
    s_mul_i32 s56, s62, 2560
    s_add_u32 s56, s56, 0xd00000
    buffer_store_dwordx4 v[126:129], v8, s[12:15], s56 offen sc1
    buffer_store_dwordx4 v[142:145], v8, s[12:15], s56 offen offset:1024 sc1
    buffer_store_dwordx2 v[146:147], v9, s[12:15], s56 offen offset:2048 sc1
    buffer_load_dwordx4 v[66:69], v8, s[12:15], s78 offen offset:3072 sc1
    s_add_u32 s78, s78, 4096
    buffer_load_dwordx4 v[70:73], v8, s[12:15], s78 offen offset:0 sc1
    buffer_load_dwordx4 v[74:77], v8, s[12:15], s78 offen offset:1024 sc1
    buffer_load_dwordx4 v[78:81], v8, s[12:15], s78 offen offset:2048 sc1
    buffer_load_dwordx4 v[82:85], v8, s[12:15], s78 offen offset:3072 sc1
    s_add_u32 s78, s78, 4096
    buffer_load_dwordx4 v[86:89], v8, s[12:15], s78 offen offset:0 sc1
    buffer_load_dwordx4 v[90:93], v8, s[12:15], s78 offen offset:1024 sc1
    buffer_load_dwordx4 v[94:97], v8, s[12:15], s78 offen offset:2048 sc1
    s_waitcnt vmcnt(8)
    s_mov_b64 exec, 1
    s_cmp_lg_u32 s54, 0
    s_cbranch_scc0 L_alt_13
    buffer_store_dword v7, v6, s[12:15], s65 offen
    s_branch L_join_14
L_alt_13:
    buffer_store_dword v7, v6, s[12:15], s65 offen sc1
L_join_14:
    s_mov_b64 exec, -1
    s_mul_i32 s56, s52, 86
    s_lshr_b32 s56, s56, 8
    s_mul_i32 s56, s56, 3
    s_sub_u32 s57, s52, s56
    s_mul_i32 s57, s57, 1
    s_add_u32 s56, s57, 0
    s_cmp_ge_u32 s56, 3
    s_cselect_b32 s79, 3, 0
    s_sub_u32 s56, s56, s79
    s_add_u32 s79, s56, s3
    s_add_u32 s79, s79, 1
    s_and_b32 s79, s79, 3
    s_mul_i32 s56, s56, 5120
    s_mul_i32 s55, s79, 15360
    s_add_u32 s56, s56, s55
    s_add_u32 s56, s56, 81920
    v_add_u32 v11, s56, v8
    s_add_u32 s56, s57, 1
    s_cmp_ge_u32 s56, 3
    s_cselect_b32 s80, 3, 0
    s_sub_u32 s56, s56, s80
    s_add_u32 s80, s56, s3
    s_add_u32 s80, s80, 1
    s_and_b32 s80, s80, 3
    s_mul_i32 s56, s56, 5120
    s_mul_i32 s55, s80, 15360
    s_add_u32 s56, s56, s55
    s_add_u32 s56, s56, 81920
    v_add_u32 v12, s56, v8
    s_add_u32 s56, s57, 2
    s_cmp_ge_u32 s56, 3
    s_cselect_b32 s81, 3, 0
    s_sub_u32 s56, s56, s81
    s_add_u32 s81, s56, s3
    s_add_u32 s81, s81, 1
    s_and_b32 s81, s81, 3
    s_mul_i32 s56, s56, 5120
    s_mul_i32 s55, s81, 15360
    s_add_u32 s56, s56, s55
    s_add_u32 s56, s56, 81920
    v_add_u32 v13, s56, v8
    s_mov_b32 s82, s3
    s_mul_i32 s56, s3, 15360
    s_add_u32 s56, s56, 81920
    v_add_u32 v14, s56, v8
    s_lshl_b32 s56, s53, 2
    s_add_u32 s56, s56, s3
    s_mul_i32 s56, s56, 20480
    s_add_u32 s56, s56, 0xd00000
    s_mul_i32 s83, s79, 2560
    s_add_u32 s83, s83, s56
    s_add_u32 s84, s83, 10240
    s_mul_i32 s85, s80, 2560
    s_add_u32 s85, s85, s56
    s_add_u32 s86, s85, 10240
    s_mul_i32 s87, s81, 2560
    s_add_u32 s87, s87, s56
    s_add_u32 s88, s87, 10240
    s_mul_i32 s89, s82, 2560
    s_add_u32 s89, s89, s56
    s_add_u32 s90, s89, 10240
    v_lshlrev_b32 v118, 16, v132
    v_and_b32 v119, 0xffff0000, v132
    v_lshlrev_b32 v120, 16, v133
    v_and_b32 v121, 0xffff0000, v133
    v_lshlrev_b32 v122, 16, v134
    v_and_b32 v123, 0xffff0000, v134
    v_lshlrev_b32 v124, 16, v135
    v_and_b32 v125, 0xffff0000, v135
    v_lshlrev_b32 v126, 16, v136
    v_and_b32 v127, 0xffff0000, v136
    v_lshlrev_b32 v128, 16, v137
    v_and_b32 v129, 0xffff0000, v137
    v_lshlrev_b32 v142, 16, v138
    v_and_b32 v143, 0xffff0000, v138
    v_lshlrev_b32 v144, 16, v139
    v_and_b32 v145, 0xffff0000, v139
    v_lshlrev_b32 v146, 16, v140
    v_and_b32 v147, 0xffff0000, v140
    v_lshlrev_b32 v148, 16, v141
    v_and_b32 v149, 0xffff0000, v141
    v_mfma_f32_16x16x32_bf16 v[20:23], a[148:151], v[32:35], v[20:23]
    v_mfma_f32_16x16x32_bf16 v[24:27], a[152:155], v[32:35], v[24:27]
    v_mfma_f32_16x16x32_bf16 v[28:31], a[156:159], v[32:35], v[28:31]
    v_mfma_f32_16x16x32_bf16 v[20:23], a[160:163], v[32:35], v[20:23]
    v_mfma_f32_16x16x32_bf16 v[24:27], a[164:167], v[32:35], v[24:27]
    v_mfma_f32_16x16x32_bf16 v[28:31], a[168:171], v[32:35], v[28:31]
    v_mfma_f32_16x16x32_bf16 v[20:23], a[172:175], v[32:35], v[20:23]
    v_mfma_f32_16x16x32_bf16 v[24:27], a[176:179], v[32:35], v[24:27]
    v_mfma_f32_16x16x32_bf16 v[28:31], a[180:183], v[32:35], v[28:31]
    v_mfma_f32_16x16x32_bf16 v[20:23], a[184:187], v[32:35], v[20:23]
    v_mfma_f32_16x16x32_bf16 v[24:27], a[188:191], v[32:35], v[24:27]
    v_mfma_f32_16x16x32_bf16 v[28:31], a[192:195], v[32:35], v[28:31]
    v_mfma_f32_16x16x32_bf16 v[20:23], a[196:199], v[32:35], v[20:23]
    v_mfma_f32_16x16x32_bf16 v[24:27], a[200:203], v[32:35], v[24:27]
    v_mfma_f32_16x16x32_bf16 v[28:31], a[204:207], v[32:35], v[28:31]
    v_mfma_f32_16x16x32_bf16 v[20:23], a[208:211], v[32:35], v[20:23]
    v_mfma_f32_16x16x32_bf16 v[24:27], a[212:215], v[32:35], v[24:27]
    v_mfma_f32_16x16x32_bf16 v[28:31], a[216:219], v[32:35], v[28:31]
    v_mfma_f32_16x16x32_bf16 v[20:23], a[220:223], v[32:35], v[20:23]
    v_mfma_f32_16x16x32_bf16 v[24:27], a[224:227], v[32:35], v[24:27]
    v_mfma_f32_16x16x32_bf16 v[28:31], a[228:231], v[32:35], v[28:31]
    v_mfma_f32_16x16x32_bf16 v[20:23], a[232:235], v[32:35], v[20:23]
    v_mfma_f32_16x16x32_bf16 v[24:27], a[236:239], v[32:35], v[24:27]
    v_mfma_f32_16x16x32_bf16 v[28:31], a[240:243], v[32:35], v[28:31]
    s_mul_i32 s56, s53, 384
    s_add_u32 s56, s56, 0xc40000
    s_lshl_b32 s57, s3, 5
    s_add_u32 s56, s56, s57
    s_mov_b32 exec_lo, 0xff
    s_mov_b32 exec_hi, 0x0
    s_mov_b32 s55, 0
L_poll_15:
    buffer_load_dword v4, v10, s[12:15], s56 offen sc1
    s_add_u32 s55, s55, 1
    s_cmp_gt_u32 s55, 262144
    s_cbranch_scc1 L_pollout_16
    s_waitcnt vmcnt(0)
    v_cmp_ne_u32 vcc, s70, v4
    s_cbranch_vccnz L_poll_15
L_pollout_16:
    s_waitcnt vmcnt(0)
    s_mov_b64 exec, -1
    buffer_load_dwordx4 v[190:193], v8, s[12:15], s83 offen offset:0 sc1
    buffer_load_dwordx4 v[194:197], v8, s[12:15], s83 offen offset:1024 sc1
    buffer_load_dwordx2 v[198:199], v9, s[12:15], s83 offen offset:2048 sc1
    buffer_load_dwordx2 v[200:201], v9, s[12:15], s84 offen offset:2048 sc1
    buffer_load_dwordx4 v[202:205], v8, s[12:15], s84 offen offset:0 sc1
    buffer_load_dwordx4 v[206:209], v8, s[12:15], s84 offen offset:1024 sc1
    buffer_load_dwordx4 v[210:213], v8, s[12:15], s85 offen offset:0 sc1
    buffer_load_dwordx4 v[214:217], v8, s[12:15], s85 offen offset:1024 sc1
    buffer_load_dwordx2 v[218:219], v9, s[12:15], s85 offen offset:2048 sc1
    buffer_load_dwordx2 v[220:221], v9, s[12:15], s86 offen offset:2048 sc1
    buffer_load_dwordx4 v[222:225], v8, s[12:15], s86 offen offset:0 sc1
    buffer_load_dwordx4 v[226:229], v8, s[12:15], s86 offen offset:1024 sc1
    s_waitcnt vmcnt(11)
    v_mfma_f32_16x16x32_bf16 v[150:153], a[0:3], v[190:193], 0
    buffer_load_dwordx4 v[230:233], v8, s[12:15], s87 offen offset:0 sc1
    v_mfma_f32_16x16x32_bf16 v[154:157], a[4:7], v[190:193], 0
    v_mfma_f32_16x16x32_bf16 v[158:161], a[8:11], v[190:193], 0
    v_mfma_f32_16x16x32_bf16 v[162:165], a[12:15], v[190:193], 0
    buffer_load_dwordx4 v[234:237], v8, s[12:15], s87 offen offset:1024 sc1
    v_mfma_f32_16x16x32_bf16 v[166:169], a[16:19], v[190:193], 0
    s_waitcnt vmcnt(12)
    v_mfma_f32_16x16x32_bf16 v[150:153], a[20:23], v[194:197], v[150:153]
    v_mfma_f32_16x16x32_bf16 v[154:157], a[24:27], v[194:197], v[154:157]
    buffer_load_dwordx2 v[238:239], v9, s[12:15], s87 offen offset:2048 sc1
    v_mfma_f32_16x16x32_bf16 v[158:161], a[28:31], v[194:197], v[158:161]
    v_mfma_f32_16x16x32_bf16 v[162:165], a[32:35], v[194:197], v[162:165]
    buffer_load_dwordx2 v[240:241], v9, s[12:15], s88 offen offset:2048 sc1
    v_mfma_f32_16x16x32_bf16 v[166:169], a[36:39], v[194:197], v[166:169]
    s_waitcnt vmcnt(12)
    v_mfma_f32_16x16x32_bf16 v[150:153], a[40:43], v[198:201], v[150:153]
    v_mfma_f32_16x16x32_bf16 v[154:157], a[44:47], v[198:201], v[154:157]
    buffer_load_dwordx4 v[242:245], v8, s[12:15], s88 offen offset:0 sc1
    v_mfma_f32_16x16x32_bf16 v[158:161], a[48:51], v[198:201], v[158:161]
    v_mfma_f32_16x16x32_bf16 v[162:165], a[52:55], v[198:201], v[162:165]
    v_mfma_f32_16x16x32_bf16 v[166:169], a[56:59], v[198:201], v[166:169]
    buffer_load_dwordx4 v[246:249], v8, s[12:15], s88 offen offset:1024 sc1
    s_waitcnt vmcnt(13)
    v_mfma_f32_16x16x32_bf16 v[150:153], a[60:63], v[202:205], v[150:153]
    v_mfma_f32_16x16x32_bf16 v[154:157], a[64:67], v[202:205], v[154:157]
    v_mfma_f32_16x16x32_bf16 v[158:161], a[68:71], v[202:205], v[158:161]
    buffer_load_dwordx4 v[98:101], v8, s[12:15], s78 offen offset:3072 sc1
    v_mfma_f32_16x16x32_bf16 v[162:165], a[72:75], v[202:205], v[162:165]
    v_mfma_f32_16x16x32_bf16 v[166:169], a[76:79], v[202:205], v[166:169]
    s_waitcnt vmcnt(13)
    v_mfma_f32_16x16x32_bf16 v[150:153], a[80:83], v[206:209], v[150:153]
    s_add_u32 s78, s78, 4096
    buffer_load_dwordx4 v[102:105], v8, s[12:15], s78 offen offset:0 sc1
    v_mfma_f32_16x16x32_bf16 v[154:157], a[84:87], v[206:209], v[154:157]
    v_mfma_f32_16x16x32_bf16 v[158:161], a[88:91], v[206:209], v[158:161]
    buffer_load_dwordx4 v[106:109], v8, s[12:15], s78 offen offset:1024 sc1
    v_mfma_f32_16x16x32_bf16 v[162:165], a[92:95], v[206:209], v[162:165]
    v_mfma_f32_16x16x32_bf16 v[166:169], a[96:99], v[206:209], v[166:169]
    s_waitcnt vmcnt(14)
    v_mfma_f32_16x16x32_bf16 v[170:173], a[0:3], v[210:213], 0
    buffer_load_dwordx4 v[190:193], v8, s[12:15], s89 offen offset:0 sc1
    v_mfma_f32_16x16x32_bf16 v[174:177], a[4:7], v[210:213], 0
    v_mfma_f32_16x16x32_bf16 v[178:181], a[8:11], v[210:213], 0
    v_mfma_f32_16x16x32_bf16 v[182:185], a[12:15], v[210:213], 0
    ds_write_b128 v11, v[150:153] offset:0
    v_mfma_f32_16x16x32_bf16 v[186:189], a[16:19], v[210:213], 0
    buffer_load_dwordx4 v[194:197], v8, s[12:15], s89 offen offset:1024 sc1
    s_waitcnt vmcnt(15)
    v_mfma_f32_16x16x32_bf16 v[170:173], a[20:23], v[214:217], v[170:173]
    v_mfma_f32_16x16x32_bf16 v[174:177], a[24:27], v[214:217], v[174:177]
    ds_write_b128 v11, v[154:157] offset:1024
    v_mfma_f32_16x16x32_bf16 v[178:181], a[28:31], v[214:217], v[178:181]
    buffer_load_dwordx2 v[198:199], v9, s[12:15], s89 offen offset:2048 sc1
    v_mfma_f32_16x16x32_bf16 v[182:185], a[32:35], v[214:217], v[182:185]
    v_mfma_f32_16x16x32_bf16 v[186:189], a[36:39], v[214:217], v[186:189]
    ds_write_b128 v11, v[158:161] offset:2048
    s_waitcnt vmcnt(14)
    v_mfma_f32_16x16x32_bf16 v[170:173], a[40:43], v[218:221], v[170:173]
    buffer_load_dwordx2 v[200:201], v9, s[12:15], s90 offen offset:2048 sc1
    v_mfma_f32_16x16x32_bf16 v[174:177], a[44:47], v[218:221], v[174:177]
    v_mfma_f32_16x16x32_bf16 v[178:181], a[48:51], v[218:221], v[178:181]
    ds_write_b128 v11, v[162:165] offset:3072
    v_mfma_f32_16x16x32_bf16 v[182:185], a[52:55], v[218:221], v[182:185]
    buffer_load_dwordx4 v[202:205], v8, s[12:15], s90 offen offset:0 sc1
    v_mfma_f32_16x16x32_bf16 v[186:189], a[56:59], v[218:221], v[186:189]
    buffer_load_dwordx4 v[206:209], v8, s[12:15], s90 offen offset:1024 sc1
    s_waitcnt vmcnt(16)
    v_mfma_f32_16x16x32_bf16 v[170:173], a[60:63], v[222:225], v[170:173]
    ds_write_b128 v11, v[166:169] offset:4096
    v_mfma_f32_16x16x32_bf16 v[174:177], a[64:67], v[222:225], v[174:177]
    v_mfma_f32_16x16x32_bf16 v[178:181], a[68:71], v[222:225], v[178:181]
    buffer_load_dwordx4 v[110:113], v8, s[12:15], s78 offen offset:2048 sc1
    v_mfma_f32_16x16x32_bf16 v[182:185], a[72:75], v[222:225], v[182:185]
    v_mfma_f32_16x16x32_bf16 v[186:189], a[76:79], v[222:225], v[186:189]
    s_waitcnt vmcnt(16)
    v_mfma_f32_16x16x32_bf16 v[170:173], a[80:83], v[226:229], v[170:173]
    buffer_load_dwordx4 v[114:117], v8, s[12:15], s78 offen offset:3072 sc1
    v_mfma_f32_16x16x32_bf16 v[174:177], a[84:87], v[226:229], v[174:177]
    v_mfma_f32_16x16x32_bf16 v[178:181], a[88:91], v[226:229], v[178:181]
    v_mfma_f32_16x16x32_bf16 v[182:185], a[92:95], v[226:229], v[182:185]
    s_add_u32 m0, s73, 0
    s_nop 0
    buffer_load_dwordx4 v8, s[12:15], s72 offen offset:0 sc1 lds
    v_mfma_f32_16x16x32_bf16 v[186:189], a[96:99], v[226:229], v[186:189]
    s_waitcnt vmcnt(17)
    v_mfma_f32_16x16x32_bf16 v[150:153], a[0:3], v[230:233], 0
    v_mfma_f32_16x16x32_bf16 v[154:157], a[4:7], v[230:233], 0
    s_add_u32 m0, s73, 0
    s_nop 0
    buffer_load_dwordx4 v8, s[12:15], s72 offen offset:1024 sc1 lds
    v_mfma_f32_16x16x32_bf16 v[158:161], a[8:11], v[230:233], 0
    v_mfma_f32_16x16x32_bf16 v[162:165], a[12:15], v[230:233], 0
    ds_write_b128 v12, v[170:173] offset:0
    v_mfma_f32_16x16x32_bf16 v[166:169], a[16:19], v[230:233], 0
    s_add_u32 m0, s73, 0
    s_nop 0
    buffer_load_dwordx4 v8, s[12:15], s72 offen offset:2048 sc1 lds
    s_waitcnt vmcnt(18)
    v_mfma_f32_16x16x32_bf16 v[150:153], a[20:23], v[234:237], v[150:153]
    v_mfma_f32_16x16x32_bf16 v[154:157], a[24:27], v[234:237], v[154:157]
    ds_write_b128 v12, v[174:177] offset:1024
    v_mfma_f32_16x16x32_bf16 v[158:161], a[28:31], v[234:237], v[158:161]
    s_add_u32 m0, s73, 0
    s_nop 0
    buffer_load_dwordx4 v8, s[12:15], s72 offen offset:3072 sc1 lds
    v_mfma_f32_16x16x32_bf16 v[162:165], a[32:35], v[234:237], v[162:165]
    v_mfma_f32_16x16x32_bf16 v[166:169], a[36:39], v[234:237], v[166:169]
    ds_write_b128 v12, v[178:181] offset:2048
    s_waitcnt vmcnt(17)
    v_mfma_f32_16x16x32_bf16 v[150:153], a[40:43], v[238:241], v[150:153]
    s_add_u32 m0, s73, 4096
    s_add_u32 s72, s72, 4096
    buffer_load_dwordx4 v8, s[12:15], s72 offen offset:0 sc1 lds
    v_mfma_f32_16x16x32_bf16 v[154:157], a[44:47], v[238:241], v[154:157]
    v_mfma_f32_16x16x32_bf16 v[158:161], a[48:51], v[238:241], v[158:161]
    ds_write_b128 v12, v[182:185] offset:3072
    v_mfma_f32_16x16x32_bf16 v[162:165], a[52:55], v[238:241], v[162:165]
    s_add_u32 m0, s73, 4096
    s_nop 0
    buffer_load_dwordx4 v8, s[12:15], s72 offen offset:1024 sc1 lds
    v_mfma_f32_16x16x32_bf16 v[166:169], a[56:59], v[238:241], v[166:169]
    s_add_u32 m0, s73, 4096
    s_nop 0
    buffer_load_dwordx4 v8, s[12:15], s72 offen offset:2048 sc1 lds
    s_waitcnt vmcnt(19)
    v_mfma_f32_16x16x32_bf16 v[150:153], a[60:63], v[242:245], v[150:153]
    ds_write_b128 v12, v[186:189] offset:4096
    v_mfma_f32_16x16x32_bf16 v[154:157], a[64:67], v[242:245], v[154:157]
    v_mfma_f32_16x16x32_bf16 v[158:161], a[68:71], v[242:245], v[158:161]
    s_add_u32 m0, s73, 4096
    s_nop 0
    buffer_load_dwordx4 v8, s[12:15], s72 offen offset:3072 sc1 lds
    v_mfma_f32_16x16x32_bf16 v[162:165], a[72:75], v[242:245], v[162:165]
    v_mfma_f32_16x16x32_bf16 v[166:169], a[76:79], v[242:245], v[166:169]
    s_waitcnt vmcnt(19)
    v_mfma_f32_16x16x32_bf16 v[150:153], a[80:83], v[246:249], v[150:153]
    s_add_u32 m0, s73, 8192
    s_add_u32 s72, s72, 4096
    buffer_load_dwordx4 v8, s[12:15], s72 offen offset:0 sc1 lds
    v_mfma_f32_16x16x32_bf16 v[154:157], a[84:87], v[246:249], v[154:157]
    v_mfma_f32_16x16x32_bf16 v[158:161], a[88:91], v[246:249], v[158:161]
    v_mfma_f32_16x16x32_bf16 v[162:165], a[92:95], v[246:249], v[162:165]
    s_add_u32 m0, s73, 8192
    s_nop 0
    buffer_load_dwordx4 v8, s[12:15], s72 offen offset:1024 sc1 lds
    v_mfma_f32_16x16x32_bf16 v[166:169], a[96:99], v[246:249], v[166:169]
    s_waitcnt vmcnt(17)
    v_mfma_f32_16x16x32_bf16 v[118:121], a[0:3], v[190:193], v[118:121]
    s_add_u32 m0, s73, 8192
    s_nop 0
    buffer_load_dwordx4 v8, s[12:15], s72 offen offset:2048 sc1 lds
    v_mfma_f32_16x16x32_bf16 v[122:125], a[4:7], v[190:193], v[122:125]
    v_mfma_f32_16x16x32_bf16 v[126:129], a[8:11], v[190:193], v[126:129]
    v_mfma_f32_16x16x32_bf16 v[142:145], a[12:15], v[190:193], v[142:145]
    ds_write_b128 v13, v[150:153] offset:0
    v_mfma_f32_16x16x32_bf16 v[146:149], a[16:19], v[190:193], v[146:149]
    s_add_u32 m0, s73, 8192
    s_nop 0
    buffer_load_dwordx4 v8, s[12:15], s72 offen offset:3072 sc1 lds
    s_waitcnt vmcnt(18)
    v_mfma_f32_16x16x32_bf16 v[118:121], a[20:23], v[194:197], v[118:121]
    v_mfma_f32_16x16x32_bf16 v[122:125], a[24:27], v[194:197], v[122:125]
    ds_write_b128 v13, v[154:157] offset:1024
    v_mfma_f32_16x16x32_bf16 v[126:129], a[28:31], v[194:197], v[126:129]
    s_add_u32 m0, s73, 12288
    s_add_u32 s72, s72, 4096
    buffer_load_dwordx4 v8, s[12:15], s72 offen offset:0 sc1 lds
    v_mfma_f32_16x16x32_bf16 v[142:145], a[32:35], v[194:197], v[142:145]
    v_mfma_f32_16x16x32_bf16 v[146:149], a[36:39], v[194:197], v[146:149]
    ds_write_b128 v13, v[158:161] offset:2048
    s_waitcnt vmcnt(17)
    v_mfma_f32_16x16x32_bf16 v[118:121], a[40:43], v[198:201], v[118:121]
    s_add_u32 m0, s73, 12288
    s_nop 0
    buffer_load_dwordx4 v8, s[12:15], s72 offen offset:1024 sc1 lds
    v_mfma_f32_16x16x32_bf16 v[122:125], a[44:47], v[198:201], v[122:125]
    s_add_u32 m0, s73, 12288
    s_nop 0
    buffer_load_dwordx4 v8, s[12:15], s72 offen offset:2048 sc1 lds
    v_mfma_f32_16x16x32_bf16 v[126:129], a[48:51], v[198:201], v[126:129]
    ds_write_b128 v13, v[162:165] offset:3072
    v_mfma_f32_16x16x32_bf16 v[142:145], a[52:55], v[198:201], v[142:145]
    v_mfma_f32_16x16x32_bf16 v[146:149], a[56:59], v[198:201], v[146:149]
    s_add_u32 m0, s73, 12288
    s_nop 0
    buffer_load_dwordx4 v8, s[12:15], s72 offen offset:3072 sc1 lds
    s_waitcnt vmcnt(19)
    v_mfma_f32_16x16x32_bf16 v[118:121], a[60:63], v[202:205], v[118:121]
    ds_write_b128 v13, v[166:169] offset:4096
    v_mfma_f32_16x16x32_bf16 v[122:125], a[64:67], v[202:205], v[122:125]
    v_mfma_f32_16x16x32_bf16 v[126:129], a[68:71], v[202:205], v[126:129]
    s_waitcnt lgkmcnt(0)
    s_barrier
    v_mfma_f32_16x16x32_bf16 v[142:145], a[72:75], v[202:205], v[142:145]
    ds_read_b128 v[210:213], v14 offset:0
    ds_read_b128 v[214:217], v14 offset:1024
    v_mfma_f32_16x16x32_bf16 v[146:149], a[76:79], v[202:205], v[146:149]
    ds_read_b128 v[218:221], v14 offset:2048
    ds_read_b128 v[222:225], v14 offset:3072
    s_waitcnt vmcnt(18)
    v_mfma_f32_16x16x32_bf16 v[118:121], a[80:83], v[206:209], v[118:121]
    ds_read_b128 v[226:229], v14 offset:4096
    ds_read_b128 v[230:233], v14 offset:5120
    v_mfma_f32_16x16x32_bf16 v[122:125], a[84:87], v[206:209], v[122:125]
    ds_read_b128 v[234:237], v14 offset:6144
    ds_read_b128 v[238:241], v14 offset:7168
    v_mfma_f32_16x16x32_bf16 v[126:129], a[88:91], v[206:209], v[126:129]
    ds_read_b128 v[242:245], v14 offset:8192
    ds_read_b128 v[246:249], v14 offset:9216
    v_mfma_f32_16x16x32_bf16 v[142:145], a[92:95], v[206:209], v[142:145]
    ds_read_b128 v[170:173], v14 offset:10240
    ds_read_b128 v[174:177], v14 offset:11264
    v_mfma_f32_16x16x32_bf16 v[146:149], a[96:99], v[206:209], v[146:149]
    ds_read_b128 v[178:181], v14 offset:12288
    ds_read_b128 v[182:185], v14 offset:13312
    ds_read_b128 v[186:189], v14 offset:14336
    s_waitcnt lgkmcnt(9)
    v_pk_add_f32 v[210:211], v[210:211], v[230:231]
    s_add_u32 m0, s73, 16384
    s_add_u32 s72, s72, 4096
    buffer_load_dwordx4 v8, s[12:15], s72 offen offset:0 sc1 lds
    v_pk_add_f32 v[212:213], v[212:213], v[232:233]
    s_waitcnt lgkmcnt(8)
    v_pk_add_f32 v[214:215], v[214:215], v[234:235]
    v_pk_add_f32 v[216:217], v[216:217], v[236:237]
    s_add_u32 m0, s73, 16384
    s_nop 0
    buffer_load_dwordx4 v8, s[12:15], s72 offen offset:1024 sc1 lds
    s_waitcnt lgkmcnt(7)
    v_pk_add_f32 v[218:219], v[218:219], v[238:239]
    v_pk_add_f32 v[220:221], v[220:221], v[240:241]
    s_waitcnt lgkmcnt(6)
    v_pk_add_f32 v[222:223], v[222:223], v[242:243]
    v_pk_add_f32 v[224:225], v[224:225], v[244:245]
    s_waitcnt lgkmcnt(5)
    v_pk_add_f32 v[226:227], v[226:227], v[246:247]
    s_add_u32 m0, s73, 16384
    s_nop 0
    buffer_load_dwordx4 v8, s[12:15], s72 offen offset:2048 sc1 lds
    v_pk_add_f32 v[228:229], v[228:229], v[248:249]
    s_waitcnt lgkmcnt(4)
    v_pk_add_f32 v[210:211], v[210:211], v[170:171]
    v_pk_add_f32 v[212:213], v[212:213], v[172:173]
    s_waitcnt lgkmcnt(3)
    v_pk_add_f32 v[214:215], v[214:215], v[174:175]
    v_pk_add_f32 v[216:217], v[216:217], v[176:177]
    s_waitcnt lgkmcnt(2)
    v_pk_add_f32 v[218:219], v[218:219], v[178:179]
    v_pk_add_f32 v[220:221], v[220:221], v[180:181]
    s_waitcnt lgkmcnt(1)
    v_pk_add_f32 v[222:223], v[222:223], v[182:183]
    v_pk_add_f32 v[224:225], v[224:225], v[184:185]
    s_waitcnt lgkmcnt(0)
    v_pk_add_f32 v[226:227], v[226:227], v[186:187]
    v_pk_add_f32 v[228:229], v[228:229], v[188:189]
    v_pk_add_f32 v[118:119], v[118:119], v[210:211]
    v_pk_add_f32 v[120:121], v[120:121], v[212:213]
    v_pk_add_f32 v[122:123], v[122:123], v[214:215]
    v_pk_add_f32 v[124:125], v[124:125], v[216:217]
    v_pk_add_f32 v[126:127], v[126:127], v[218:219]
    v_pk_add_f32 v[128:129], v[128:129], v[220:221]
    v_pk_add_f32 v[142:143], v[142:143], v[222:223]
    v_pk_add_f32 v[144:145], v[144:145], v[224:225]
    v_pk_add_f32 v[146:147], v[146:147], v[226:227]
    v_pk_add_f32 v[148:149], v[148:149], v[228:229]
    v_cvt_pk_bf16_f32 v132, v118, v119
    v_cvt_pk_bf16_f32 v133, v120, v121
    v_cvt_pk_bf16_f32 v134, v122, v123
    v_cvt_pk_bf16_f32 v135, v124, v125
    v_cvt_pk_bf16_f32 v136, v126, v127
    v_cvt_pk_bf16_f32 v137, v128, v129
    v_cvt_pk_bf16_f32 v138, v142, v143
    v_cvt_pk_bf16_f32 v139, v144, v145
    v_cvt_pk_bf16_f32 v140, v146, v147
    v_cvt_pk_bf16_f32 v141, v148, v149
    s_mul_i32 s56, s62, 2560
    s_add_u32 s56, s56, 0x1000000
    buffer_store_dwordx4 v[132:135], v8, s[12:15], s56 offen sc1
    buffer_store_dwordx4 v[136:139], v8, s[12:15], s56 offen offset:1024 sc1
    buffer_store_dwordx2 v[140:141], v9, s[12:15], s56 offen offset:2048 sc1
    v_mov_b32 v150, 0
    v_mov_b32 v151, 0
    v_mov_b32 v152, 0x3f803f80
    v_dot2c_f32_bf16 v150, v132, v152
    v_dot2c_f32_bf16 v151, v132, v132
    v_dot2c_f32_bf16 v150, v133, v152
    v_dot2c_f32_bf16 v151, v133, v133
    v_dot2c_f32_bf16 v150, v134, v152
    v_dot2c_f32_bf16 v151, v134, v134
    v_dot2c_f32_bf16 v150, v135, v152
    v_dot2c_f32_bf16 v151, v135, v135
    v_dot2c_f32_bf16 v150, v136, v152
    v_dot2c_f32_bf16 v151, v136, v136
    v_dot2c_f32_bf16 v150, v137, v152
    v_dot2c_f32_bf16 v151, v137, v137
    v_dot2c_f32_bf16 v150, v138, v152
    v_dot2c_f32_bf16 v151, v138, v138
    v_dot2c_f32_bf16 v150, v139, v152
    v_dot2c_f32_bf16 v151, v139, v139
    v_dot2c_f32_bf16 v150, v140, v152
    v_dot2c_f32_bf16 v151, v140, v140
    v_dot2c_f32_bf16 v150, v141, v152
    v_dot2c_f32_bf16 v151, v141, v141
    s_nop 2
    v_permlane32_swap_b32 v150, v151
    v_add_f32 v150, v150, v151
    v_mov_b32 v4, v150
    s_nop 1
    v_permlane16_swap_b32 v150, v4
    v_add_f32 v150, v150, v4
    v_mov_b32 v151, v150
    s_nop 1
    v_permlane32_swap_b32 v150, v151
    s_lshl_b32 s56, s62, 7
    s_add_u32 s56, s56, 0xc20000
    s_mov_b32 exec_lo, 0xffff
    s_mov_b32 exec_hi, 0x0
    buffer_store_dwordx2 v[150:151], v9, s[12:15], s56 offen sc1
    s_mov_b64 exec, -1
    buffer_load_dwordx4 a[0:3], v8, s[12:15], s72 offen offset:3072 sc1
    s_add_u32 s72, s72, 4096
    buffer_load_dwordx4 a[4:7], v8, s[12:15], s72 offen offset:0 sc1
    buffer_load_dwordx4 a[8:11], v8, s[12:15], s72 offen offset:1024 sc1
    buffer_load_dwordx4 a[12:15], v8, s[12:15], s72 offen offset:2048 sc1
    buffer_load_dwordx4 a[16:19], v8, s[12:15], s72 offen offset:3072 sc1
    s_add_u32 s72, s72, 4096
    buffer_load_dwordx4 a[20:23], v8, s[12:15], s72 offen offset:0 sc1
    buffer_load_dwordx4 a[24:27], v8, s[12:15], s72 offen offset:1024 sc1
    buffer_load_dwordx4 a[28:31], v8, s[12:15], s72 offen offset:2048 sc1
    s_add_u32 s56, s65, 128
    s_waitcnt vmcnt(8)
    s_mov_b64 exec, 1
    s_cmp_lg_u32 s54, 0
    s_cbranch_scc0 L_alt_17
    buffer_store_dword v7, v6, s[12:15], s56 offen
    s_branch L_join_18
L_alt_17:
    buffer_store_dword v7, v6, s[12:15], s56 offen sc1
L_join_18:
    s_mov_b64 exec, -1
    buffer_load_dwordx4 a[32:35], v8, s[12:15], s72 offen offset:3072 sc1
    s_add_u32 s72, s72, 4096
    buffer_load_dwordx4 a[36:39], v8, s[12:15], s72 offen offset:0 sc1
    buffer_load_dwordx4 a[40:43], v8, s[12:15], s72 offen offset:1024 sc1
    buffer_load_dwordx4 a[44:47], v8, s[12:15], s72 offen offset:2048 sc1
    s_mul_i32 s74, s53, 81920
    s_add_u32 s74, s74, s58
    s_add_u32 s74, s74, 0x1000000
    v_lshlrev_b32 v4, 7, v2
    v_lshl_add_u32 v4, v3, 3, v4
    v_add_u32 v4, 77824, v4
    s_lshl_b32 s75, s53, 2
    s_add_u32 s75, s75, s3
    s_lshl_b32 s75, s75, 10
    s_add_u32 s75, s75, 0xc20000
    v_add_u32 v36, 81920, v8
    v_add_u32 v37, 122880, v8
    v_add_u32 v130, 81920, v9
    v_add_u32 v131, 122880, v9
    v_mfma_f32_16x16x32_bf16 v[20:23], a[244:247], v[32:35], v[20:23]
    v_mfma_f32_16x16x32_bf16 v[24:27], a[248:251], v[32:35], v[24:27]
    v_mfma_f32_16x16x32_bf16 v[28:31], a[252:255], v[32:35], v[28:31]
    v_mfma_f32_16x16x32_bf16 v[20:23], v[16:19], v[32:35], v[20:23]
    v_mfma_f32_16x16x32_bf16 v[24:27], v[38:41], v[32:35], v[24:27]
    v_mfma_f32_16x16x32_bf16 v[28:31], v[42:45], v[32:35], v[28:31]
    v_mfma_f32_16x16x32_bf16 v[20:23], v[46:49], v[32:35], v[20:23]
    v_mfma_f32_16x16x32_bf16 v[24:27], v[50:53], v[32:35], v[24:27]
    v_mfma_f32_16x16x32_bf16 v[28:31], v[54:57], v[32:35], v[28:31]
    v_mfma_f32_16x16x32_bf16 v[20:23], v[58:61], v[32:35], v[20:23]
    v_mfma_f32_16x16x32_bf16 v[24:27], v[62:65], v[32:35], v[24:27]
    v_mfma_f32_16x16x32_bf16 v[28:31], v[66:69], v[32:35], v[28:31]
    v_mfma_f32_16x16x32_bf16 v[20:23], v[70:73], v[32:35], v[20:23]
    v_mfma_f32_16x16x32_bf16 v[24:27], v[74:77], v[32:35], v[24:27]
    v_mfma_f32_16x16x32_bf16 v[28:31], v[78:81], v[32:35], v[28:31]
    v_mfma_f32_16x16x32_bf16 v[20:23], v[82:85], v[32:35], v[20:23]
    v_mfma_f32_16x16x32_bf16 v[24:27], v[86:89], v[32:35], v[24:27]
    v_mfma_f32_16x16x32_bf16 v[28:31], v[90:93], v[32:35], v[28:31]
    v_mfma_f32_16x16x32_bf16 v[20:23], v[94:97], v[32:35], v[20:23]
    v_mfma_f32_16x16x32_bf16 v[24:27], v[98:101], v[32:35], v[24:27]
    v_mfma_f32_16x16x32_bf16 v[28:31], v[102:105], v[32:35], v[28:31]
    v_mfma_f32_16x16x32_bf16 v[20:23], v[106:109], v[32:35], v[20:23]
    v_mfma_f32_16x16x32_bf16 v[24:27], v[110:113], v[32:35], v[24:27]
    v_mfma_f32_16x16x32_bf16 v[28:31], v[114:117], v[32:35], v[28:31]
    s_mul_i32 s56, s53, 384
    s_add_u32 s56, s56, 0xc40080
    s_mov_b32 exec_lo, 0xffffffff
    s_mov_b32 exec_hi, 0x0
    s_mov_b32 s55, 0
L_poll_19:
    buffer_load_dword v5, v10, s[12:15], s56 offen sc1
    s_add_u32 s55, s55, 1
    s_cmp_gt_u32 s55, 262144
    s_cbranch_scc1 L_pollout_20
    s_waitcnt vmcnt(0)
    v_cmp_ne_u32 vcc, s70, v5
    s_cbranch_vccnz L_poll_19
L_pollout_20:
    s_waitcnt vmcnt(0)
    s_mov_b64 exec, -1
    s_add_u32 m0, s58, 81920
    s_nop 0
    buffer_load_dwordx4 v8, s[12:15], s74 offen offset:0 sc1 lds
    buffer_load_dwordx4 v8, s[12:15], s74 offen offset:1024 sc1 lds
    buffer_load_dwordx4 v8, s[12:15], s74 offen offset:2048 sc1 lds
    buffer_load_dwordx4 v8, s[12:15], s74 offen offset:3072 sc1 lds
    s_add_u32 s74, s74, 4096
    s_add_u32 m0, s58, 86016
    s_nop 0
    buffer_load_dwordx4 v8, s[12:15], s74 offen offset:0 sc1 lds
    s_add_u32 s74, s74, 16384
    s_lshl_b32 m0, s3, 10
    s_nop 0
    s_add_u32 m0, m0, 77824
    s_nop 0
    buffer_load_dwordx4 v8, s[12:15], s75 offen sc1 lds
    s_add_u32 m0, s58, 102400
    s_nop 0
    buffer_load_dwordx4 v8, s[12:15], s74 offen offset:0 sc1 lds
    buffer_load_dwordx4 v8, s[12:15], s74 offen offset:1024 sc1 lds
    buffer_load_dwordx4 v8, s[12:15], s74 offen offset:2048 sc1 lds
    buffer_load_dwordx4 v8, s[12:15], s74 offen offset:3072 sc1 lds
    s_lshl_b32 s56, s53, 3
    s_add_u32 s56, s56, s52
    s_mul_i32 s56, s56, 24576
    s_add_u32 s56, s56, 0x1300000
    s_lshl_b32 s76, s3, 10
    s_add_u32 s76, s76, s56
    s_lshl_b32 s83, s3, 9
    s_add_u32 s83, s83, s56
    s_add_u32 s83, s83, 4096
    s_waitcnt vmcnt(5)
    s_barrier
    ds_read_b128 v[194:197], v36 offset:0
    ds_read_b128 v[198:201], v36 offset:2560
    ds_read_b128 v[202:205], v36 offset:5120
    ds_read_b128 v[206:209], v36 offset:7680
    s_waitcnt lgkmcnt(3)
    v_mfma_f32_16x16x32_bf16 v[118:121], a[100:103], v[194:197], 0
    ds_read_b128 v[210:213], v36 offset:1024
    v_mfma_f32_16x16x32_bf16 v[122:125], a[104:107], v[194:197], 0
    s_add_u32 s74, s74, 4096
    s_add_u32 m0, s58, 106496
    s_nop 0
    buffer_load_dwordx4 v8, s[12:15], s74 offen offset:0 sc1 lds
    s_add_u32 s74, s74, 16384
    v_mfma_f32_16x16x32_bf16 v[126:129], a[108:111], v[194:197], 0
    s_add_u32 m0, s58, 122880
    s_nop 0
    buffer_load_dwordx4 v8, s[12:15], s74 offen offset:0 sc1 lds
    s_waitcnt lgkmcnt(3)
    v_mfma_f32_16x16x32_bf16 v[158:161], a[100:103], v[198:201], 0
    ds_read_b128 v[214:217], v36 offset:3584
    v_mfma_f32_16x16x32_bf16 v[162:165], a[104:107], v[198:201], 0
    v_mfma_f32_16x16x32_bf16 v[166:169], a[108:111], v[198:201], 0
    s_waitcnt lgkmcnt(3)
    v_mfma_f32_16x16x32_bf16 v[170:173], a[100:103], v[202:205], 0
    ds_read_b128 v[218:221], v36 offset:6144
    v_mfma_f32_16x16x32_bf16 v[174:177], a[104:107], v[202:205], 0
    v_mfma_f32_16x16x32_bf16 v[178:181], a[108:111], v[202:205], 0
    s_waitcnt lgkmcnt(3)
    v_mfma_f32_16x16x32_bf16 v[182:185], a[100:103], v[206:209], 0
    ds_read_b128 v[222:225], v36 offset:8704
    v_mfma_f32_16x16x32_bf16 v[186:189], a[104:107], v[206:209], 0
    buffer_load_dwordx4 v8, s[12:15], s74 offen offset:1024 sc1 lds
    v_mfma_f32_16x16x32_bf16 v[190:193], a[108:111], v[206:209], 0
    s_waitcnt lgkmcnt(3)
    v_mfma_f32_16x16x32_bf16 v[118:121], a[112:115], v[210:213], v[118:121]
    ds_read_b64 v[194:195], v130 offset:2048
    ds_read_b64 v[196:197], v130 offset:12288
    v_mfma_f32_16x16x32_bf16 v[122:125], a[116:119], v[210:213], v[122:125]
    v_mfma_f32_16x16x32_bf16 v[126:129], a[120:123], v[210:213], v[126:129]
    s_waitcnt lgkmcnt(4)
    v_mfma_f32_16x16x32_bf16 v[158:161], a[112:115], v[214:217], v[158:161]
    ds_read_b64 v[198:199], v130 offset:4608
    ds_read_b64 v[200:201], v130 offset:14848
    v_mfma_f32_16x16x32_bf16 v[162:165], a[116:119], v[214:217], v[162:165]
    buffer_load_dwordx4 v8, s[12:15], s74 offen offset:2048 sc1 lds
    v_mfma_f32_16x16x32_bf16 v[166:169], a[120:123], v[214:217], v[166:169]
    s_waitcnt lgkmcnt(5)
    v_mfma_f32_16x16x32_bf16 v[170:173], a[112:115], v[218:221], v[170:173]
    ds_read_b64 v[202:203], v130 offset:7168
    ds_read_b64 v[204:205], v130 offset:17408
    v_mfma_f32_16x16x32_bf16 v[174:177], a[116:119], v[218:221], v[174:177]
    v_mfma_f32_16x16x32_bf16 v[178:181], a[120:123], v[218:221], v[178:181]
    s_waitcnt lgkmcnt(6)
    v_mfma_f32_16x16x32_bf16 v[182:185], a[112:115], v[222:225], v[182:185]
    ds_read_b64 v[206:207], v130 offset:9728
    ds_read_b64 v[208:209], v130 offset:19968
    v_mfma_f32_16x16x32_bf16 v[186:189], a[116:119], v[222:225], v[186:189]
    buffer_load_dwordx4 v8, s[12:15], s74 offen offset:3072 sc1 lds
    v_mfma_f32_16x16x32_bf16 v[190:193], a[120:123], v[222:225], v[190:193]
    s_waitcnt lgkmcnt(6)
    v_mfma_f32_16x16x32_bf16 v[118:121], a[124:127], v[194:197], v[118:121]
    ds_read_b128 v[210:213], v36 offset:10240
    v_mfma_f32_16x16x32_bf16 v[122:125], a[128:131], v[194:197], v[122:125]
    v_mfma_f32_16x16x32_bf16 v[126:129], a[132:135], v[194:197], v[126:129]
    s_waitcnt lgkmcnt(5)
    v_mfma_f32_16x16x32_bf16 v[158:161], a[124:127], v[198:201], v[158:161]
    ds_read_b128 v[214:217], v36 offset:12800
    v_mfma_f32_16x16x32_bf16 v[162:165], a[128:131], v[198:201], v[162:165]
    s_add_u32 s74, s74, 4096
    s_add_u32 m0, s58, 126976
    s_nop 0
    buffer_load_dwordx4 v8, s[12:15], s74 offen offset:0 sc1 lds
    s_add_u32 s74, s74, 16384
    v_mfma_f32_16x16x32_bf16 v[166:169], a[132:135], v[198:201], v[166:169]
    s_waitcnt lgkmcnt(4)
    v_mfma_f32_16x16x32_bf16 v[170:173], a[124:127], v[202:205], v[170:173]
    ds_read_b128 v[218:221], v36 offset:15360
    v_mfma_f32_16x16x32_bf16 v[174:177], a[128:131], v[202:205], v[174:177]
    v_mfma_f32_16x16x32_bf16 v[178:181], a[132:135], v[202:205], v[178:181]
    s_waitcnt lgkmcnt(3)
    v_mfma_f32_16x16x32_bf16 v[182:185], a[124:127], v[206:209], v[182:185]
    ds_read_b128 v[222:225], v36 offset:17920
    v_mfma_f32_16x16x32_bf16 v[186:189], a[128:131], v[206:209], v[186:189]
    s_add_u32 m0, s58, 143360
    s_nop 0
    buffer_load_dwordx4 v8, s[12:15], s74 offen offset:0 sc1 lds
    v_mfma_f32_16x16x32_bf16 v[190:193], a[132:135], v[206:209], v[190:193]
    s_waitcnt lgkmcnt(3)
    v_mfma_f32_16x16x32_bf16 v[118:121], a[136:139], v[210:213], v[118:121]
    ds_read_b128 v[194:197], v36 offset:11264
    v_mfma_f32_16x16x32_bf16 v[122:125], a[140:143], v[210:213], v[122:125]
    v_mfma_f32_16x16x32_bf16 v[126:129], a[144:147], v[210:213], v[126:129]
    s_waitcnt lgkmcnt(3)
    v_mfma_f32_16x16x32_bf16 v[158:161], a[136:139], v[214:217], v[158:161]
    ds_read_b128 v[198:201], v36 offset:13824
    v_mfma_f32_16x16x32_bf16 v[162:165], a[140:143], v[214:217], v[162:165]
    buffer_load_dwordx4 v8, s[12:15], s74 offen offset:1024 sc1 lds
    v_mfma_f32_16x16x32_bf16 v[166:169], a[144:147], v[214:217], v[166:169]
    s_waitcnt lgkmcnt(3)
    v_mfma_f32_16x16x32_bf16 v[170:173], a[136:139], v[218:221], v[170:173]
    ds_read_b128 v[202:205], v36 offset:16384
    v_mfma_f32_16x16x32_bf16 v[174:177], a[140:143], v[218:221], v[174:177]
    v_mfma_f32_16x16x32_bf16 v[178:181], a[144:147], v[218:221], v[178:181]
    s_waitcnt lgkmcnt(3)
    v_mfma_f32_16x16x32_bf16 v[182:185], a[136:139], v[222:225], v[182:185]
    ds_read_b128 v[206:209], v36 offset:18944
    v_mfma_f32_16x16x32_bf16 v[186:189], a[140:143], v[222:225], v[186:189]
    buffer_load_dwordx4 v8, s[12:15], s74 offen offset:2048 sc1 lds
    v_mfma_f32_16x16x32_bf16 v[190:193], a[144:147], v[222:225], v[190:193]
    s_waitcnt lgkmcnt(3)
    v_mfma_f32_16x16x32_bf16 v[118:121], a[148:151], v[194:197], v[118:121]
    buffer_load_dwordx4 v8, s[12:15], s74 offen offset:3072 sc1 lds
    s_add_u32 s74, s74, 4096
    s_add_u32 m0, s58, 147456
    s_nop 0
    buffer_load_dwordx4 v8, s[12:15], s74 offen offset:0 sc1 lds
    s_add_u32 s74, s74, 16384
    s_waitcnt vmcnt(10)
    s_barrier
    ds_read_b128 v[210:213], v36 offset:20480
    v_mfma_f32_16x16x32_bf16 v[122:125], a[152:155], v[194:197], v[122:125]
    v_mfma_f32_16x16x32_bf16 v[126:129], a[156:159], v[194:197], v[126:129]
    buffer_load_dwordx4 a[48:51], v8, s[12:15], s72 offen offset:3072 sc1
    s_waitcnt lgkmcnt(3)
    v_mfma_f32_16x16x32_bf16 v[158:161], a[148:151], v[198:201], v[158:161]
    ds_read_b128 v[214:217], v36 offset:23040
    v_mfma_f32_16x16x32_bf16 v[162:165], a[152:155], v[198:201], v[162:165]
    v_mfma_f32_16x16x32_bf16 v[166:169], a[156:159], v[198:201], v[166:169]
    s_waitcnt lgkmcnt(3)
    v_mfma_f32_16x16x32_bf16 v[170:173], a[148:151], v[202:205], v[170:173]
    ds_read_b128 v[218:221], v36 offset:25600
    v_mfma_f32_16x16x32_bf16 v[174:177], a[152:155], v[202:205], v[174:177]
    v_mfma_f32_16x16x32_bf16 v[178:181], a[156:159], v[202:205], v[178:181]
    s_add_u32 s72, s72, 4096
    buffer_load_dwordx4 a[52:55], v8, s[12:15], s72 offen offset:0 sc1
    s_waitcnt lgkmcnt(3)
    v_mfma_f32_16x16x32_bf16 v[182:185], a[148:151], v[206:209], v[182:185]
    ds_read_b128 v[222:225], v36 offset:28160
    v_mfma_f32_16x16x32_bf16 v[186:189], a[152:155], v[206:209], v[186:189]
    v_mfma_f32_16x16x32_bf16 v[190:193], a[156:159], v[206:209], v[190:193]
    s_waitcnt lgkmcnt(3)
    v_mfma_f32_16x16x32_bf16 v[118:121], a[160:163], v[210:213], v[118:121]
    ds_read_b128 v[194:197], v36 offset:21504
    v_mfma_f32_16x16x32_bf16 v[122:125], a[164:167], v[210:213], v[122:125]
    v_mfma_f32_16x16x32_bf16 v[126:129], a[168:171], v[210:213], v[126:129]
    s_waitcnt lgkmcnt(3)
    v_mfma_f32_16x16x32_bf16 v[158:161], a[160:163], v[214:217], v[158:161]
    ds_read_b128 v[198:201], v36 offset:24064
    v_mfma_f32_16x16x32_bf16 v[162:165], a[164:167], v[214:217], v[162:165]
    buffer_load_dwordx4 a[56:59], v8, s[12:15], s72 offen offset:1024 sc1
    v_mfma_f32_16x16x32_bf16 v[166:169], a[168:171], v[214:217], v[166:169]
    s_waitcnt lgkmcnt(3)
    v_mfma_f32_16x16x32_bf16 v[170:173], a[160:163], v[218:221], v[170:173]
    ds_read_b128 v[202:205], v36 offset:26624
    v_mfma_f32_16x16x32_bf16 v[174:177], a[164:167], v[218:221], v[174:177]
    v_mfma_f32_16x16x32_bf16 v[178:181], a[168:171], v[218:221], v[178:181]
    s_waitcnt lgkmcnt(3)
    v_mfma_f32_16x16x32_bf16 v[182:185], a[160:163], v[222:225], v[182:185]
    ds_read_b128 v[206:209], v36 offset:29184
    v_mfma_f32_16x16x32_bf16 v[186:189], a[164:167], v[222:225], v[186:189]
    buffer_load_dwordx4 a[60:63], v8, s[12:15], s72 offen offset:2048 sc1
    v_mfma_f32_16x16x32_bf16 v[190:193], a[168:171], v[222:225], v[190:193]
    s_waitcnt lgkmcnt(3)
    v_mfma_f32_16x16x32_bf16 v[118:121], a[172:175], v[194:197], v[118:121]
    ds_read_b64 v[210:211], v130 offset:22528
    ds_read_b64 v[212:213], v130 offset:32768
    v_mfma_f32_16x16x32_bf16 v[122:125], a[176:179], v[194:197], v[122:125]
    v_mfma_f32_16x16x32_bf16 v[126:129], a[180:183], v[194:197], v[126:129]
    s_waitcnt lgkmcnt(4)
    v_mfma_f32_16x16x32_bf16 v[158:161], a[172:175], v[198:201], v[158:161]
    ds_read_b64 v[214:215], v130 offset:25088
    ds_read_b64 v[216:217], v130 offset:35328
    v_mfma_f32_16x16x32_bf16 v[162:165], a[176:179], v[198:201], v[162:165]
    buffer_load_dwordx4 a[64:67], v8, s[12:15], s72 offen offset:3072 sc1
    v_mfma_f32_16x16x32_bf16 v[166:169], a[180:183], v[198:201], v[166:169]
    s_waitcnt lgkmcnt(5)
    v_mfma_f32_16x16x32_bf16 v[170:173], a[172:175], v[202:205], v[170:173]
    ds_read_b64 v[218:219], v130 offset:27648
    ds_read_b64 v[220:221], v130 offset:37888
    v_mfma_f32_16x16x32_bf16 v[174:177], a[176:179], v[202:205], v[174:177]
    v_mfma_f32_16x16x32_bf16 v[178:181], a[180:183], v[202:205], v[178:181]
    s_waitcnt lgkmcnt(6)
    v_mfma_f32_16x16x32_bf16 v[182:185], a[172:175], v[206:209], v[182:185]
    ds_read_b64 v[222:223], v130 offset:30208
    ds_read_b64 v[224:225], v130 offset:40448
    v_mfma_f32_16x16x32_bf16 v[186:189], a[176:179], v[206:209], v[186:189]
    s_add_u32 s72, s72, 4096
    buffer_load_dwordx4 a[68:71], v8, s[12:15], s72 offen offset:0 sc1
    v_mfma_f32_16x16x32_bf16 v[190:193], a[180:183], v[206:209], v[190:193]
    s_waitcnt lgkmcnt(6)
    v_mfma_f32_16x16x32_bf16 v[118:121], a[184:187], v[210:213], v[118:121]
    ds_read_b128 v[194:197], v36 offset:30720
    v_mfma_f32_16x16x32_bf16 v[122:125], a[188:191], v[210:213], v[122:125]
    v_mfma_f32_16x16x32_bf16 v[126:129], a[192:195], v[210:213], v[126:129]
    s_waitcnt lgkmcnt(5)
    v_mfma_f32_16x16x32_bf16 v[158:161], a[184:187], v[214:217], v[158:161]
    ds_read_b128 v[198:201], v36 offset:33280
    v_mfma_f32_16x16x32_bf16 v[162:165], a[188:191], v[214:217], v[162:165]
    buffer_load_dwordx4 a[72:75], v8, s[12:15], s72 offen offset:1024 sc1
    v_mfma_f32_16x16x32_bf16 v[166:169], a[192:195], v[214:217], v[166:169]
    s_waitcnt lgkmcnt(4)
    v_mfma_f32_16x16x32_bf16 v[170:173], a[184:187], v[218:221], v[170:173]
    ds_read_b128 v[202:205], v36 offset:35840
    v_mfma_f32_16x16x32_bf16 v[174:177], a[188:191], v[218:221], v[174:177]
    v_mfma_f32_16x16x32_bf16 v[178:181], a[192:195], v[218:221], v[178:181]
    s_waitcnt lgkmcnt(3)
    v_mfma_f32_16x16x32_bf16 v[182:185], a[184:187], v[222:225], v[182:185]
    ds_read_b128 v[206:209], v36 offset:38400
    v_mfma_f32_16x16x32_bf16 v[186:189], a[188:191], v[222:225], v[186:189]
    buffer_load_dwordx4 a[76:79], v8, s[12:15], s72 offen offset:2048 sc1
    v_mfma_f32_16x16x32_bf16 v[190:193], a[192:195], v[222:225], v[190:193]
    s_waitcnt lgkmcnt(3)
    v_mfma_f32_16x16x32_bf16 v[118:121], a[196:199], v[194:197], v[118:121]
    ds_read_b128 v[210:213], v36 offset:31744
    v_mfma_f32_16x16x32_bf16 v[122:125], a[200:203], v[194:197], v[122:125]
    v_mfma_f32_16x16x32_bf16 v[126:129], a[204:207], v[194:197], v[126:129]
    s_waitcnt lgkmcnt(3)
    v_mfma_f32_16x16x32_bf16 v[158:161], a[196:199], v[198:201], v[158:161]
    ds_read_b128 v[214:217], v36 offset:34304
    v_mfma_f32_16x16x32_bf16 v[162:165], a[200:203], v[198:201], v[162:165]
    buffer_load_dwordx4 a[80:83], v8, s[12:15], s72 offen offset:3072 sc1
    v_mfma_f32_16x16x32_bf16 v[166:169], a[204:207], v[198:201], v[166:169]
    s_waitcnt lgkmcnt(3)
    v_mfma_f32_16x16x32_bf16 v[170:173], a[196:199], v[202:205], v[170:173]
    ds_read_b128 v[218:221], v36 offset:36864
    v_mfma_f32_16x16x32_bf16 v[174:177], a[200:203], v[202:205], v[174:177]
    v_mfma_f32_16x16x32_bf16 v[178:181], a[204:207], v[202:205], v[178:181]
    s_waitcnt lgkmcnt(3)
    v_mfma_f32_16x16x32_bf16 v[182:185], a[196:199], v[206:209], v[182:185]
    ds_read_b128 v[222:225], v36 offset:39424
    v_mfma_f32_16x16x32_bf16 v[186:189], a[200:203], v[206:209], v[186:189]
    s_add_u32 s72, s72, 4096
    buffer_load_dwordx4 a[84:87], v8, s[12:15], s72 offen offset:0 sc1
    v_mfma_f32_16x16x32_bf16 v[190:193], a[204:207], v[206:209], v[190:193]
    s_waitcnt lgkmcnt(3)
    v_mfma_f32_16x16x32_bf16 v[118:121], a[208:211], v[210:213], v[118:121]
    s_waitcnt vmcnt(15)
    s_barrier
    ds_read_b128 v[194:197], v37 offset:0
    v_mfma_f32_16x16x32_bf16 v[122:125], a[212:215], v[210:213], v[122:125]
    v_mfma_f32_16x16x32_bf16 v[126:129], a[216:219], v[210:213], v[126:129]
    s_waitcnt lgkmcnt(3)
    v_mfma_f32_16x16x32_bf16 v[158:161], a[208:211], v[214:217], v[158:161]
    ds_read_b128 v[198:201], v37 offset:2560
    v_mfma_f32_16x16x32_bf16 v[162:165], a[212:215], v[214:217], v[162:165]
    buffer_load_dwordx4 a[88:91], v8, s[12:15], s72 offen offset:1024 sc1
    v_mfma_f32_16x16x32_bf16 v[166:169], a[216:219], v[214:217], v[166:169]
    s_waitcnt lgkmcnt(3)
    v_mfma_f32_16x16x32_bf16 v[170:173], a[208:211], v[218:221], v[170:173]
    ds_read_b128 v[202:205], v37 offset:5120
    v_mfma_f32_16x16x32_bf16 v[174:177], a[212:215], v[218:221], v[174:177]
    v_mfma_f32_16x16x32_bf16 v[178:181], a[216:219], v[218:221], v[178:181]
    s_waitcnt lgkmcnt(3)
    v_mfma_f32_16x16x32_bf16 v[182:185], a[208:211], v[222:225], v[182:185]
    ds_read_b128 v[206:209], v37 offset:7680
    v_mfma_f32_16x16x32_bf16 v[186:189], a[212:215], v[222:225], v[186:189]
    buffer_load_dwordx4 a[92:95], v8, s[12:15], s72 offen offset:2048 sc1
    v_mfma_f32_16x16x32_bf16 v[190:193], a[216:219], v[222:225], v[190:193]
    s_waitcnt lgkmcnt(3)
    v_mfma_f32_16x16x32_bf16 v[118:121], a[220:223], v[194:197], v[118:121]
    ds_read_b128 v[210:213], v37 offset:1024
    v_mfma_f32_16x16x32_bf16 v[122:125], a[224:227], v[194:197], v[122:125]
    v_mfma_f32_16x16x32_bf16 v[126:129], a[228:231], v[194:197], v[126:129]
    s_waitcnt lgkmcnt(3)
    v_mfma_f32_16x16x32_bf16 v[158:161], a[220:223], v[198:201], v[158:161]
    ds_read_b128 v[214:217], v37 offset:3584
    v_mfma_f32_16x16x32_bf16 v[162:165], a[224:227], v[198:201], v[162:165]
    buffer_load_dwordx4 a[96:99], v8, s[12:15], s72 offen offset:3072 sc1
    v_mfma_f32_16x16x32_bf16 v[166:169], a[228:231], v[198:201], v[166:169]
    s_waitcnt lgkmcnt(3)
    v_mfma_f32_16x16x32_bf16 v[170:173], a[220:223], v[202:205], v[170:173]
    ds_read_b128 v[218:221], v37 offset:6144
    v_mfma_f32_16x16x32_bf16 v[174:177], a[224:227], v[202:205], v[174:177]
    v_mfma_f32_16x16x32_bf16 v[178:181], a[228:231], v[202:205], v[178:181]
    s_waitcnt lgkmcnt(3)
    v_mfma_f32_16x16x32_bf16 v[182:185], a[220:223], v[206:209], v[182:185]
    ds_read_b128 v[222:225], v37 offset:8704
    v_mfma_f32_16x16x32_bf16 v[186:189], a[224:227], v[206:209], v[186:189]
    v_mfma_f32_16x16x32_bf16 v[190:193], a[228:231], v[206:209], v[190:193]
    s_add_u32 s72, s72, 4096
    buffer_load_dwordx4 a[100:103], v8, s[12:15], s72 offen offset:0 sc1
    s_waitcnt lgkmcnt(3)
    v_mfma_f32_16x16x32_bf16 v[118:121], a[232:235], v[210:213], v[118:121]
    ds_read_b64 v[194:195], v131 offset:2048
    ds_read_b64 v[196:197], v131 offset:12288
    v_mfma_f32_16x16x32_bf16 v[122:125], a[236:239], v[210:213], v[122:125]
    ds_read_b64 v[142:143], v4 offset:0
    ds_read_b64 v[144:145], v4 offset:512
    v_mfma_f32_16x16x32_bf16 v[126:129], a[240:243], v[210:213], v[126:129]
    ds_read_b64 v[146:147], v4 offset:1024
    s_waitcnt lgkmcnt(7)
    v_mfma_f32_16x16x32_bf16 v[158:161], a[232:235], v[214:217], v[158:161]
    ds_read_b64 v[198:199], v131 offset:4608
    ds_read_b64 v[200:201], v131 offset:14848
    v_mfma_f32_16x16x32_bf16 v[162:165], a[236:239], v[214:217], v[162:165]
    ds_read_b64 v[148:149], v4 offset:1536
    ds_read_b64 v[150:151], v4 offset:2048
    v_mfma_f32_16x16x32_bf16 v[166:169], a[240:243], v[214:217], v[166:169]
    ds_read_b64 v[152:153], v4 offset:2560
    s_waitcnt lgkmcnt(11)
    v_mfma_f32_16x16x32_bf16 v[170:173], a[232:235], v[218:221], v[170:173]
    ds_read_b64 v[202:203], v131 offset:7168
    ds_read_b64 v[204:205], v131 offset:17408
    v_mfma_f32_16x16x32_bf16 v[174:177], a[236:239], v[218:221], v[174:177]
    ds_read_b64 v[154:155], v4 offset:3072
    ds_read_b64 v[156:157], v4 offset:3584
    v_mfma_f32_16x16x32_bf16 v[178:181], a[240:243], v[218:221], v[178:181]
    s_waitcnt lgkmcnt(10)
    v_add_f32 v142, v142, v144
    v_mfma_f32_16x16x32_bf16 v[182:185], a[232:235], v[222:225], v[182:185]
    ds_read_b64 v[206:207], v131 offset:9728
    ds_read_b64 v[208:209], v131 offset:19968
    v_mfma_f32_16x16x32_bf16 v[186:189], a[236:239], v[222:225], v[186:189]
    v_add_f32 v143, v143, v145
    s_waitcnt lgkmcnt(11)
    v_add_f32 v142, v142, v146
    v_mfma_f32_16x16x32_bf16 v[190:193], a[240:243], v[222:225], v[190:193]
    v_add_f32 v143, v143, v147
    v_mfma_f32_16x16x32_bf16 v[118:121], a[244:247], v[194:197], v[118:121]
    ds_read_b128 v[210:213], v37 offset:10240
    v_mfma_f32_16x16x32_bf16 v[122:125], a[248:251], v[194:197], v[122:125]
    s_waitcnt lgkmcnt(9)
    v_add_f32 v142, v142, v148
    v_add_f32 v143, v143, v149
    v_mfma_f32_16x16x32_bf16 v[126:129], a[252:255], v[194:197], v[126:129]
    s_waitcnt lgkmcnt(8)
    v_add_f32 v142, v142, v150
    v_mfma_f32_16x16x32_bf16 v[158:161], a[244:247], v[198:201], v[158:161]
    ds_read_b128 v[214:217], v37 offset:12800
    v_mfma_f32_16x16x32_bf16 v[162:165], a[248:251], v[198:201], v[162:165]
    v_add_f32 v143, v143, v151
    s_waitcnt lgkmcnt(8)
    v_add_f32 v142, v142, v152
    v_mfma_f32_16x16x32_bf16 v[166:169], a[252:255], v[198:201], v[166:169]
    v_add_f32 v143, v143, v153
    s_waitcnt lgkmcnt(6)
    v_mfma_f32_16x16x32_bf16 v[170:173], a[244:247], v[202:205], v[170:173]
    ds_read_b128 v[218:221], v37 offset:15360
    v_mfma_f32_16x16x32_bf16 v[174:177], a[248:251], v[202:205], v[174:177]
    s_waitcnt lgkmcnt(6)
    v_add_f32 v142, v142, v154
    v_add_f32 v143, v143, v155
    v_mfma_f32_16x16x32_bf16 v[178:181], a[252:255], v[202:205], v[178:181]
    s_waitcnt lgkmcnt(5)
    v_add_f32 v142, v142, v156
    s_waitcnt lgkmcnt(3)
    v_mfma_f32_16x16x32_bf16 v[182:185], a[244:247], v[206:209], v[182:185]
    ds_read_b128 v[222:225], v37 offset:17920
    v_mfma_f32_16x16x32_bf16 v[186:189], a[248:251], v[206:209], v[186:189]
    v_add_f32 v143, v143, v157
    v_mul_f32 v142, 0x3acccccd, v142
    v_mul_f32 v143, 0x3acccccd, v143
    v_fma_f32 v143, -v142, v142, v143
    v_max_f32 v143, 0, v143
    v_add_f32 v143, 0x3727c5ac, v143
    v_rsq_f32 v144, v143
    v_mfma_f32_16x16x32_bf16 v[190:193], a[252:255], v[206:209], v[190:193]
    v_mov_b32 v146, v142
    v_mov_b32 v148, v142
    s_nop 1
    v_permlane32_swap_b32 v146, v148
    s_waitcnt lgkmcnt(3)
    v_mfma_f32_16x16x32_bf16 v[118:121], v[16:19], v[210:213], v[118:121]
    ds_read_b128 v[194:197], v37 offset:11264
    v_mfma_f32_16x16x32_bf16 v[122:125], v[38:41], v[210:213], v[122:125]
    v_mov_b32 v147, v146
    v_mov_b32 v149, v148
    s_nop 0
    v_permlane16_swap_b32 v146, v147
    v_permlane16_swap_b32 v148, v149
    s_lshl_b32 s57, s3, 6
    v_lshl_add_u32 v143, v3, 2, s57
    ds_bpermute_b32 v238, v143, v144
    v_mfma_f32_16x16x32_bf16 v[126:129], v[42:45], v[210:213], v[126:129]
    buffer_load_dwordx4 a[104:107], v8, s[12:15], s72 offen offset:1024 sc1
    s_waitcnt lgkmcnt(4)
    v_mfma_f32_16x16x32_bf16 v[158:161], v[16:19], v[214:217], v[158:161]
    ds_read_b128 v[198:201], v37 offset:13824
    v_mfma_f32_16x16x32_bf16 v[162:165], v[38:41], v[214:217], v[162:165]
    buffer_load_dwordx4 a[108:111], v8, s[12:15], s72 offen offset:2048 sc1
    v_mfma_f32_16x16x32_bf16 v[166:169], v[42:45], v[214:217], v[166:169]
    buffer_load_dwordx4 a[112:115], v8, s[12:15], s72 offen offset:3072 sc1
    s_waitcnt lgkmcnt(4)
    v_mfma_f32_16x16x32_bf16 v[170:173], v[16:19], v[218:221], v[170:173]
    ds_read_b128 v[202:205], v37 offset:16384
    v_mfma_f32_16x16x32_bf16 v[174:177], v[38:41], v[218:221], v[174:177]
    s_add_u32 s72, s72, 4096
    buffer_load_dwordx4 a[116:119], v8, s[12:15], s72 offen offset:0 sc1
    v_mfma_f32_16x16x32_bf16 v[178:181], v[42:45], v[218:221], v[178:181]
    buffer_load_dwordx4 a[120:123], v8, s[12:15], s72 offen offset:1024 sc1
    s_waitcnt lgkmcnt(4)
    v_mfma_f32_16x16x32_bf16 v[182:185], v[16:19], v[222:225], v[182:185]
    ds_read_b128 v[206:209], v37 offset:18944
    v_mfma_f32_16x16x32_bf16 v[186:189], v[38:41], v[222:225], v[186:189]
    buffer_load_dwordx4 a[124:127], v8, s[12:15], s72 offen offset:2048 sc1
    v_mfma_f32_16x16x32_bf16 v[190:193], v[42:45], v[222:225], v[190:193]
    s_waitcnt lgkmcnt(4)
    v_mfma_f32_16x16x32_bf16 v[118:121], v[46:49], v[194:197], v[118:121]
    s_waitcnt vmcnt(20)
    s_barrier
    ds_read_b128 v[210:213], v37 offset:20480
    v_mfma_f32_16x16x32_bf16 v[122:125], v[50:53], v[194:197], v[122:125]
    v_mfma_f32_16x16x32_bf16 v[126:129], v[54:57], v[194:197], v[126:129]
    buffer_load_dwordx4 a[128:131], v8, s[12:15], s72 offen offset:3072 sc1
    s_waitcnt lgkmcnt(3)
    v_mfma_f32_16x16x32_bf16 v[158:161], v[46:49], v[198:201], v[158:161]
    ds_read_b128 v[214:217], v37 offset:21504
    v_mfma_f32_16x16x32_bf16 v[162:165], v[50:53], v[198:201], v[162:165]
    v_mfma_f32_16x16x32_bf16 v[166:169], v[54:57], v[198:201], v[166:169]
    s_waitcnt lgkmcnt(3)
    v_mfma_f32_16x16x32_bf16 v[170:173], v[46:49], v[202:205], v[170:173]
    ds_read_b64 v[218:219], v131 offset:22528
    ds_read_b64 v[220:221], v131 offset:32768
    v_mfma_f32_16x16x32_bf16 v[174:177], v[50:53], v[202:205], v[174:177]
    v_mfma_f32_16x16x32_bf16 v[178:181], v[54:57], v[202:205], v[178:181]
    s_add_u32 s72, s72, 4096
    buffer_load_dwordx4 a[132:135], v8, s[12:15], s72 offen offset:0 sc1
    s_waitcnt lgkmcnt(4)
    v_mfma_f32_16x16x32_bf16 v[182:185], v[46:49], v[206:209], v[182:185]
    ds_read_b128 v[222:225], v37 offset:30720
    v_mfma_f32_16x16x32_bf16 v[186:189], v[50:53], v[206:209], v[186:189]
    v_mfma_f32_16x16x32_bf16 v[190:193], v[54:57], v[206:209], v[190:193]
    s_waitcnt lgkmcnt(4)
    v_mfma_f32_16x16x32_bf16 v[118:121], v[58:61], v[210:213], v[118:121]
    ds_read_b128 v[194:197], v37 offset:31744
    v_mfma_f32_16x16x32_bf16 v[122:125], v[62:65], v[210:213], v[122:125]
    v_mfma_f32_16x16x32_bf16 v[126:129], v[66:69], v[210:213], v[126:129]
    buffer_load_dwordx4 a[136:139], v8, s[12:15], s72 offen offset:1024 sc1
    s_waitcnt lgkmcnt(4)
    v_mfma_f32_16x16x32_bf16 v[118:121], v[70:73], v[214:217], v[118:121]
    ds_read_b128 v[198:201], v37 offset:23040
    v_mfma_f32_16x16x32_bf16 v[122:125], v[74:77], v[214:217], v[122:125]
    v_mfma_f32_16x16x32_bf16 v[126:129], v[78:81], v[214:217], v[126:129]
    s_waitcnt lgkmcnt(3)
    v_mfma_f32_16x16x32_bf16 v[118:121], v[82:85], v[218:221], v[118:121]
    ds_read_b128 v[202:205], v37 offset:24064
    v_mfma_f32_16x16x32_bf16 v[122:125], v[86:89], v[218:221], v[122:125]
    v_mfma_f32_16x16x32_bf16 v[126:129], v[90:93], v[218:221], v[126:129]
    buffer_load_dwordx4 a[140:143], v8, s[12:15], s72 offen offset:2048 sc1
    s_waitcnt lgkmcnt(3)
    v_mfma_f32_16x16x32_bf16 v[118:121], v[94:97], v[222:225], v[118:121]
    ds_read_b64 v[206:207], v131 offset:25088
    ds_read_b64 v[208:209], v131 offset:35328
    v_mfma_f32_16x16x32_bf16 v[122:125], v[98:101], v[222:225], v[122:125]
    v_mfma_f32_16x16x32_bf16 v[126:129], v[102:105], v[222:225], v[126:129]
    s_waitcnt lgkmcnt(4)
    v_mfma_f32_16x16x32_bf16 v[118:121], v[106:109], v[194:197], v[118:121]
    ds_read_b128 v[210:213], v37 offset:33280
    v_mfma_f32_16x16x32_bf16 v[122:125], v[110:113], v[194:197], v[122:125]
    v_mfma_f32_16x16x32_bf16 v[126:129], v[114:117], v[194:197], v[126:129]
    s_waitcnt lgkmcnt(4)
    v_mfma_f32_16x16x32_bf16 v[158:161], v[58:61], v[198:201], v[158:161]
    ds_read_b128 v[214:217], v37 offset:34304
    v_mfma_f32_16x16x32_bf16 v[162:165], v[62:65], v[198:201], v[162:165]
    v_mfma_f32_16x16x32_bf16 v[166:169], v[66:69], v[198:201], v[166:169]
    s_waitcnt lgkmcnt(4)
    v_mfma_f32_16x16x32_bf16 v[158:161], v[70:73], v[202:205], v[158:161]
    ds_read_b128 v[218:221], v37 offset:25600
    v_mfma_f32_16x16x32_bf16 v[162:165], v[74:77], v[202:205], v[162:165]
    v_fma_f32 v118, -v20, v146, v118
    v_fma_f32 v119, -v21, v146, v119
    v_mfma_f32_16x16x32_bf16 v[166:169], v[78:81], v[202:205], v[166:169]
    v_fma_f32 v120, -v22, v146, v120
    s_waitcnt lgkmcnt(3)
    v_mfma_f32_16x16x32_bf16 v[158:161], v[82:85], v[206:209], v[158:161]
    ds_read_b128 v[222:225], v37 offset:26624
    v_mfma_f32_16x16x32_bf16 v[162:165], v[86:89], v[206:209], v[162:165]
    v_fma_f32 v121, -v23, v146, v121
    v_fma_f32 v122, -v24, v146, v122
    v_mfma_f32_16x16x32_bf16 v[166:169], v[90:93], v[206:209], v[166:169]
    v_fma_f32 v123, -v25, v146, v123
    s_waitcnt lgkmcnt(3)
    v_mfma_f32_16x16x32_bf16 v[158:161], v[94:97], v[210:213], v[158:161]
    ds_read_b64 v[194:195], v131 offset:27648
    ds_read_b64 v[196:197], v131 offset:37888
    v_mfma_f32_16x16x32_bf16 v[162:165], v[98:101], v[210:213], v[162:165]
    v_fma_f32 v124, -v26, v146, v124
    v_fma_f32 v125, -v27, v146, v125
    v_mfma_f32_16x16x32_bf16 v[166:169], v[102:105], v[210:213], v[166:169]
    v_fma_f32 v126, -v28, v146, v126
    s_waitcnt lgkmcnt(4)
    v_mfma_f32_16x16x32_bf16 v[158:161], v[106:109], v[214:217], v[158:161]
    ds_read_b128 v[198:201], v37 offset:35840
    v_mfma_f32_16x16x32_bf16 v[162:165], v[110:113], v[214:217], v[162:165]
    v_fma_f32 v127, -v29, v146, v127
    v_fma_f32 v128, -v30, v146, v128
    v_mfma_f32_16x16x32_bf16 v[166:169], v[114:117], v[214:217], v[166:169]
    v_fma_f32 v129, -v31, v146, v129
    v_cvt_pk_bf16_f32 v226, v118, v119
    v_cvt_pk_bf16_f32 v227, v120, v121
    v_cvt_pk_bf16_f32 v228, v122, v123
    v_cvt_pk_bf16_f32 v229, v124, v125
    v_cvt_pk_bf16_f32 v230, v126, v127
    v_cvt_pk_bf16_f32 v231, v128, v129
    v_pk_max_i16 v226, v226, 0
    v_pk_max_i16 v227, v227, 0
    v_pk_max_i16 v228, v228, 0
    v_pk_max_i16 v229, v229, 0
    v_pk_max_i16 v230, v230, 0
    v_pk_max_i16 v231, v231, 0
    buffer_store_dwordx4 v[226:229], v8, s[12:15], s76 offen sc1
    buffer_store_dwordx2 v[230:231], v9, s[12:15], s83 offen sc1
    s_add_u32 s76, s76, 6144
    s_add_u32 s83, s83, 6144
    s_waitcnt lgkmcnt(4)
    v_mfma_f32_16x16x32_bf16 v[170:173], v[58:61], v[218:221], v[170:173]
    ds_read_b128 v[202:205], v37 offset:36864
    v_mfma_f32_16x16x32_bf16 v[174:177], v[62:65], v[218:221], v[174:177]
    v_mfma_f32_16x16x32_bf16 v[178:181], v[66:69], v[218:221], v[178:181]
    s_waitcnt lgkmcnt(4)
    v_mfma_f32_16x16x32_bf16 v[170:173], v[70:73], v[222:225], v[170:173]
    ds_read_b128 v[206:209], v37 offset:28160
    v_mfma_f32_16x16x32_bf16 v[174:177], v[74:77], v[222:225], v[174:177]
    v_fma_f32 v158, -v20, v147, v158
    v_fma_f32 v159, -v21, v147, v159
    v_mfma_f32_16x16x32_bf16 v[178:181], v[78:81], v[222:225], v[178:181]
    v_fma_f32 v160, -v22, v147, v160
    s_waitcnt lgkmcnt(3)
    v_mfma_f32_16x16x32_bf16 v[170:173], v[82:85], v[194:197], v[170:173]
    ds_read_b128 v[210:213], v37 offset:29184
    v_mfma_f32_16x16x32_bf16 v[174:177], v[86:89], v[194:197], v[174:177]
    v_fma_f32 v161, -v23, v147, v161
    v_fma_f32 v162, -v24, v147, v162
    v_mfma_f32_16x16x32_bf16 v[178:181], v[90:93], v[194:197], v[178:181]
    v_fma_f32 v163, -v25, v147, v163
    s_waitcnt lgkmcnt(3)
    v_mfma_f32_16x16x32_bf16 v[170:173], v[94:97], v[198:201], v[170:173]
    ds_read_b64 v[214:215], v131 offset:30208
    ds_read_b64 v[216:217], v131 offset:40448
    v_mfma_f32_16x16x32_bf16 v[174:177], v[98:101], v[198:201], v[174:177]
    v_fma_f32 v164, -v26, v147, v164
    v_fma_f32 v165, -v27, v147, v165
    v_mfma_f32_16x16x32_bf16 v[178:181], v[102:105], v[198:201], v[178:181]
    v_fma_f32 v166, -v28, v147, v166
    s_waitcnt lgkmcnt(4)
    v_mfma_f32_16x16x32_bf16 v[170:173], v[106:109], v[202:205], v[170:173]
    ds_read_b128 v[218:221], v37 offset:38400
    v_mfma_f32_16x16x32_bf16 v[174:177], v[110:113], v[202:205], v[174:177]
    v_fma_f32 v167, -v29, v147, v167
    v_fma_f32 v168, -v30, v147, v168
    v_mfma_f32_16x16x32_bf16 v[178:181], v[114:117], v[202:205], v[178:181]
    v_fma_f32 v169, -v31, v147, v169
    v_cvt_pk_bf16_f32 v232, v158, v159
    v_cvt_pk_bf16_f32 v233, v160, v161
    v_cvt_pk_bf16_f32 v234, v162, v163
    v_cvt_pk_bf16_f32 v235, v164, v165
    v_cvt_pk_bf16_f32 v236, v166, v167
    v_cvt_pk_bf16_f32 v237, v168, v169
    v_pk_max_i16 v232, v232, 0
    v_pk_max_i16 v233, v233, 0
    v_pk_max_i16 v234, v234, 0
    v_pk_max_i16 v235, v235, 0
    v_pk_max_i16 v236, v236, 0
    v_pk_max_i16 v237, v237, 0
    buffer_store_dwordx4 v[232:235], v8, s[12:15], s76 offen sc1
    buffer_store_dwordx2 v[236:237], v9, s[12:15], s83 offen sc1
    s_add_u32 s76, s76, 6144
    s_add_u32 s83, s83, 6144
    s_waitcnt lgkmcnt(4)
    v_mfma_f32_16x16x32_bf16 v[182:185], v[58:61], v[206:209], v[182:185]
    ds_read_b128 v[222:225], v37 offset:39424
    v_mfma_f32_16x16x32_bf16 v[186:189], v[62:65], v[206:209], v[186:189]
    v_mfma_f32_16x16x32_bf16 v[190:193], v[66:69], v[206:209], v[190:193]
    s_waitcnt lgkmcnt(4)
    v_mfma_f32_16x16x32_bf16 v[182:185], v[70:73], v[210:213], v[182:185]
    v_mfma_f32_16x16x32_bf16 v[186:189], v[74:77], v[210:213], v[186:189]
    v_fma_f32 v170, -v20, v148, v170
    v_fma_f32 v171, -v21, v148, v171
    v_mfma_f32_16x16x32_bf16 v[190:193], v[78:81], v[210:213], v[190:193]
    v_fma_f32 v172, -v22, v148, v172
    s_waitcnt lgkmcnt(2)
    v_mfma_f32_16x16x32_bf16 v[182:185], v[82:85], v[214:217], v[182:185]
    v_mfma_f32_16x16x32_bf16 v[186:189], v[86:89], v[214:217], v[186:189]
    v_fma_f32 v173, -v23, v148, v173
    v_fma_f32 v174, -v24, v148, v174
    v_mfma_f32_16x16x32_bf16 v[190:193], v[90:93], v[214:217], v[190:193]
    v_fma_f32 v175, -v25, v148, v175
    s_waitcnt lgkmcnt(1)
    v_mfma_f32_16x16x32_bf16 v[182:185], v[94:97], v[218:221], v[182:185]
    v_mfma_f32_16x16x32_bf16 v[186:189], v[98:101], v[218:221], v[186:189]
    v_fma_f32 v176, -v26, v148, v176
    v_fma_f32 v177, -v27, v148, v177
    v_mfma_f32_16x16x32_bf16 v[190:193], v[102:105], v[218:221], v[190:193]
    v_fma_f32 v178, -v28, v148, v178
    s_waitcnt lgkmcnt(0)
    v_mfma_f32_16x16x32_bf16 v[182:185], v[106:109], v[222:225], v[182:185]
    v_mfma_f32_16x16x32_bf16 v[186:189], v[110:113], v[222:225], v[186:189]
    v_fma_f32 v179, -v29, v148, v179
    v_fma_f32 v180, -v30, v148, v180
    v_mfma_f32_16x16x32_bf16 v[190:193], v[114:117], v[222:225], v[190:193]
    v_fma_f32 v181, -v31, v148, v181
    v_cvt_pk_bf16_f32 v226, v170, v171
    v_cvt_pk_bf16_f32 v227, v172, v173
    v_cvt_pk_bf16_f32 v228, v174, v175
    v_cvt_pk_bf16_f32 v229, v176, v177
    v_cvt_pk_bf16_f32 v230, v178, v179
    v_cvt_pk_bf16_f32 v231, v180, v181
    v_pk_max_i16 v226, v226, 0
    v_pk_max_i16 v227, v227, 0
    v_pk_max_i16 v228, v228, 0
    v_pk_max_i16 v229, v229, 0
    v_pk_max_i16 v230, v230, 0
    v_pk_max_i16 v231, v231, 0
    buffer_store_dwordx4 v[226:229], v8, s[12:15], s76 offen sc1
    buffer_store_dwordx2 v[230:231], v9, s[12:15], s83 offen sc1
    s_add_u32 s76, s76, 6144
    s_add_u32 s83, s83, 6144
    s_barrier
    v_fma_f32 v182, -v20, v149, v182
    v_fma_f32 v183, -v21, v149, v183
    v_fma_f32 v184, -v22, v149, v184
    v_fma_f32 v185, -v23, v149, v185
    v_fma_f32 v186, -v24, v149, v186
    v_fma_f32 v187, -v25, v149, v187
    v_fma_f32 v188, -v26, v149, v188
    v_fma_f32 v189, -v27, v149, v189
    v_fma_f32 v190, -v28, v149, v190
    v_fma_f32 v191, -v29, v149, v191
    v_fma_f32 v192, -v30, v149, v192
    v_fma_f32 v193, -v31, v149, v193
    v_cvt_pk_bf16_f32 v232, v182, v183
    v_cvt_pk_bf16_f32 v233, v184, v185
    v_cvt_pk_bf16_f32 v234, v186, v187
    v_cvt_pk_bf16_f32 v235, v188, v189
    v_cvt_pk_bf16_f32 v236, v190, v191
    v_cvt_pk_bf16_f32 v237, v192, v193
    v_pk_max_i16 v232, v232, 0
    v_pk_max_i16 v233, v233, 0
    v_pk_max_i16 v234, v234, 0
    v_pk_max_i16 v235, v235, 0
    v_pk_max_i16 v236, v236, 0
    v_pk_max_i16 v237, v237, 0
    buffer_store_dwordx4 v[232:235], v8, s[12:15], s76 offen sc1
    buffer_store_dwordx2 v[236:237], v9, s[12:15], s83 offen sc1
    s_add_u32 s76, s76, 6144
    s_add_u32 s83, s83, 6144
    buffer_load_dwordx4 a[144:147], v8, s[12:15], s72 offen offset:3072 sc1
    s_add_u32 s72, s72, 4096
    buffer_load_dwordx4 a[148:151], v8, s[12:15], s72 offen offset:0 sc1
    buffer_load_dwordx4 a[152:155], v8, s[12:15], s72 offen offset:1024 sc1
    buffer_load_dwordx4 a[156:159], v8, s[12:15], s72 offen offset:2048 sc1
    buffer_load_dwordx4 a[160:163], v8, s[12:15], s72 offen offset:3072 sc1
    s_waitcnt vmcnt(5)
    s_add_u32 s56, s65, 256
    s_mov_b64 exec, 1
    s_cmp_lg_u32 s54, 0
    s_cbranch_scc0 L_alt_21
    buffer_store_dword v7, v6, s[12:15], s56 offen
    s_branch L_join_22
L_alt_21:
    buffer_store_dword v7, v6, s[12:15], s56 offen sc1
L_join_22:
    s_mov_b64 exec, -1
    v_add_u32 v4, s73, v8
    ds_read_b128 a[164:167], v4 offset:0
    ds_read_b128 a[168:171], v4 offset:1024
    ds_read_b128 a[172:175], v4 offset:2048
    ds_read_b128 a[176:179], v4 offset:3072
    ds_read_b128 a[180:183], v4 offset:4096
    ds_read_b128 a[184:187], v4 offset:5120
    ds_read_b128 a[188:191], v4 offset:6144
    ds_read_b128 a[192:195], v4 offset:7168
    ds_read_b128 a[196:199], v4 offset:8192
    ds_read_b128 a[200:203], v4 offset:9216
    ds_read_b128 a[204:207], v4 offset:10240
    ds_read_b128 a[208:211], v4 offset:11264
    ds_read_b128 a[212:215], v4 offset:12288
    ds_read_b128 a[216:219], v4 offset:13312
    ds_read_b128 a[220:223], v4 offset:14336
    ds_read_b128 a[224:227], v4 offset:15360
    ds_read_b128 a[228:231], v4 offset:16384
    ds_read_b128 a[232:235], v4 offset:17408
    ds_read_b128 a[236:239], v4 offset:18432
    s_lshl_b32 s56, s53, 2
    s_add_u32 s56, s56, s3
    s_mul_i32 s56, s56, 49152
    s_add_u32 s56, s56, 0x1300000
    s_mul_i32 s83, s79, 6144
    s_add_u32 s83, s83, s56
    s_add_u32 s84, s83, 24576
    s_mul_i32 s85, s80, 6144
    s_add_u32 s85, s85, s56
    s_add_u32 s86, s85, 24576
    s_mul_i32 s87, s81, 6144
    s_add_u32 s87, s87, s56
    s_add_u32 s88, s87, 24576
    s_mul_i32 s89, s82, 6144
    s_add_u32 s89, s89, s56
    s_add_u32 s90, s89, 24576
    v_rcp_f32 v239, v238
    v_lshlrev_b32 v16, 16, v132
    v_and_b32 v17, 0xffff0000, v132
    v_pk_mul_f32 v[16:17], v[16:17], v[238:239] op_sel:[0,1] op_sel_hi:[1,1]
    v_lshlrev_b32 v18, 16, v133
    v_and_b32 v19, 0xffff0000, v133
    v_pk_mul_f32 v[18:19], v[18:19], v[238:239] op_sel:[0,1] op_sel_hi:[1,1]
    v_lshlrev_b32 v20, 16, v134
    v_and_b32 v21, 0xffff0000, v134
    v_pk_mul_f32 v[20:21], v[20:21], v[238:239] op_sel:[0,1] op_sel_hi:[1,1]
    v_lshlrev_b32 v22, 16, v135
    v_and_b32 v23, 0xffff0000, v135
    v_pk_mul_f32 v[22:23], v[22:23], v[238:239] op_sel:[0,1] op_sel_hi:[1,1]
    v_lshlrev_b32 v24, 16, v136
    v_and_b32 v25, 0xffff0000, v136
    v_pk_mul_f32 v[24:25], v[24:25], v[238:239] op_sel:[0,1] op_sel_hi:[1,1]
    v_lshlrev_b32 v26, 16, v137
    v_and_b32 v27, 0xffff0000, v137
    v_pk_mul_f32 v[26:27], v[26:27], v[238:239] op_sel:[0,1] op_sel_hi:[1,1]
    v_lshlrev_b32 v28, 16, v138
    v_and_b32 v29, 0xffff0000, v138
    v_pk_mul_f32 v[28:29], v[28:29], v[238:239] op_sel:[0,1] op_sel_hi:[1,1]
    v_lshlrev_b32 v30, 16, v139
    v_and_b32 v31, 0xffff0000, v139
    v_pk_mul_f32 v[30:31], v[30:31], v[238:239] op_sel:[0,1] op_sel_hi:[1,1]
    v_lshlrev_b32 v32, 16, v140
    v_and_b32 v33, 0xffff0000, v140
    v_pk_mul_f32 v[32:33], v[32:33], v[238:239] op_sel:[0,1] op_sel_hi:[1,1]
    v_lshlrev_b32 v34, 16, v141
    v_and_b32 v35, 0xffff0000, v141
    v_pk_mul_f32 v[34:35], v[34:35], v[238:239] op_sel:[0,1] op_sel_hi:[1,1]
    s_mul_i32 s56, s53, 384
    s_add_u32 s56, s56, 0xc40100
    s_lshl_b32 s57, s3, 5
    s_add_u32 s56, s56, s57
    s_mov_b32 exec_lo, 0xff
    s_mov_b32 exec_hi, 0x0
    s_mov_b32 s55, 0
L_poll_23:
    buffer_load_dword v4, v10, s[12:15], s56 offen sc1
    s_add_u32 s55, s55, 1
    s_cmp_gt_u32 s55, 262144
    s_cbranch_scc1 L_pollout_24
    s_waitcnt vmcnt(0)
    v_cmp_ne_u32 vcc, s70, v4
    s_cbranch_vccnz L_poll_23
L_pollout_24:
    s_waitcnt vmcnt(0)
    s_mov_b64 exec, -1
    v_mul_u32_u24 v4, 1280, v3
    v_mad_u32_u24 v4, v2, 40, v4
    s_lshl_b32 s74, s53, 2
    s_add_u32 s74, s74, s3
    s_mul_i32 s74, s74, 20480
    s_mul_i32 s57, s52, 160
    s_add_u32 s74, s74, s57
    buffer_load_dwordx4 v[76:79], v8, s[12:15], s83 offen offset:0 sc1
    buffer_load_dwordx4 v[80:83], v8, s[12:15], s83 offen offset:1024 sc1
    buffer_load_dwordx4 v[84:87], v8, s[12:15], s83 offen offset:2048 sc1
    buffer_load_dwordx4 v[88:91], v8, s[12:15], s83 offen offset:3072 sc1
    s_add_u32 s83, s83, 4096
    buffer_load_dwordx2 v[92:93], v9, s[12:15], s83 offen offset:0 sc1
    buffer_load_dwordx2 v[94:95], v9, s[12:15], s83 offen offset:512 sc1
    buffer_load_dwordx2 v[96:97], v9, s[12:15], s83 offen offset:1024 sc1
    buffer_load_dwordx2 v[98:99], v9, s[12:15], s83 offen offset:1536 sc1
    buffer_load_dwordx4 v[100:103], v8, s[12:15], s84 offen offset:0 sc1
    buffer_load_dwordx4 v[104:107], v8, s[12:15], s84 offen offset:1024 sc1
    buffer_load_dwordx4 v[108:111], v8, s[12:15], s84 offen offset:2048 sc1
    buffer_load_dwordx4 v[112:115], v8, s[12:15], s84 offen offset:3072 sc1
    s_waitcnt vmcnt(11)
    s_waitcnt lgkmcnt(15)
    v_mfma_f32_16x16x32_bf16 v[36:39], a[164:167], v[76:79], 0
    s_add_u32 s84, s84, 4096
    buffer_load_dwordx2 v[116:117], v9, s[12:15], s84 offen offset:0 sc1
    s_waitcnt lgkmcnt(15)
    v_mfma_f32_16x16x32_bf16 v[40:43], a[168:171], v[76:79], 0
    s_waitcnt lgkmcnt(15)
    v_mfma_f32_16x16x32_bf16 v[44:47], a[172:175], v[76:79], 0
    s_waitcnt lgkmcnt(15)
    v_mfma_f32_16x16x32_bf16 v[48:51], a[176:179], v[76:79], 0
    s_waitcnt lgkmcnt(14)
    v_mfma_f32_16x16x32_bf16 v[52:55], a[180:183], v[76:79], 0
    buffer_load_dwordx2 v[118:119], v9, s[12:15], s84 offen offset:512 sc1
    s_waitcnt vmcnt(12)
    s_waitcnt lgkmcnt(13)
    v_mfma_f32_16x16x32_bf16 v[36:39], a[184:187], v[80:83], v[36:39]
    s_waitcnt lgkmcnt(12)
    v_mfma_f32_16x16x32_bf16 v[40:43], a[188:191], v[80:83], v[40:43]
    s_waitcnt lgkmcnt(11)
    v_mfma_f32_16x16x32_bf16 v[44:47], a[192:195], v[80:83], v[44:47]
    buffer_load_dwordx2 v[120:121], v9, s[12:15], s84 offen offset:1024 sc1
    s_waitcnt lgkmcnt(10)
    v_mfma_f32_16x16x32_bf16 v[48:51], a[196:199], v[80:83], v[48:51]
    s_waitcnt lgkmcnt(9)
    v_mfma_f32_16x16x32_bf16 v[52:55], a[200:203], v[80:83], v[52:55]
    s_waitcnt vmcnt(12)
    s_waitcnt lgkmcnt(8)
    v_mfma_f32_16x16x32_bf16 v[36:39], a[204:207], v[84:87], v[36:39]
    s_waitcnt lgkmcnt(7)
    v_mfma_f32_16x16x32_bf16 v[40:43], a[208:211], v[84:87], v[40:43]
    buffer_load_dwordx2 v[122:123], v9, s[12:15], s84 offen offset:1536 sc1
    s_waitcnt lgkmcnt(6)
    v_mfma_f32_16x16x32_bf16 v[44:47], a[212:215], v[84:87], v[44:47]
    s_waitcnt lgkmcnt(5)
    v_mfma_f32_16x16x32_bf16 v[48:51], a[216:219], v[84:87], v[48:51]
    s_waitcnt lgkmcnt(4)
    v_mfma_f32_16x16x32_bf16 v[52:55], a[220:223], v[84:87], v[52:55]
    s_waitcnt vmcnt(12)
    s_waitcnt lgkmcnt(3)
    v_mfma_f32_16x16x32_bf16 v[36:39], a[224:227], v[88:91], v[36:39]
    buffer_load_dwordx4 v[124:127], v8, s[12:15], s85 offen offset:0 sc1
    s_waitcnt lgkmcnt(2)
    v_mfma_f32_16x16x32_bf16 v[40:43], a[228:231], v[88:91], v[40:43]
    s_waitcnt lgkmcnt(1)
    v_mfma_f32_16x16x32_bf16 v[44:47], a[232:235], v[88:91], v[44:47]
    s_waitcnt lgkmcnt(0)
    v_mfma_f32_16x16x32_bf16 v[48:51], a[236:239], v[88:91], v[48:51]
    v_mfma_f32_16x16x32_bf16 v[52:55], a[0:3], v[88:91], v[52:55]
    buffer_load_dwordx4 v[128:131], v8, s[12:15], s85 offen offset:1024 sc1
    s_waitcnt vmcnt(12)
    v_mfma_f32_16x16x32_bf16 v[36:39], a[4:7], v[92:95], v[36:39]
    v_mfma_f32_16x16x32_bf16 v[40:43], a[8:11], v[92:95], v[40:43]
    v_mfma_f32_16x16x32_bf16 v[44:47], a[12:15], v[92:95], v[44:47]
    buffer_load_dwordx4 v[142:145], v8, s[12:15], s85 offen offset:2048 sc1
    v_mfma_f32_16x16x32_bf16 v[48:51], a[16:19], v[92:95], v[48:51]
    v_mfma_f32_16x16x32_bf16 v[52:55], a[20:23], v[92:95], v[52:55]
    s_waitcnt vmcnt(11)
    v_mfma_f32_16x16x32_bf16 v[36:39], a[24:27], v[96:99], v[36:39]
    v_mfma_f32_16x16x32_bf16 v[40:43], a[28:31], v[96:99], v[40:43]
    buffer_load_dwordx4 v[146:149], v8, s[12:15], s85 offen offset:3072 sc1
    v_mfma_f32_16x16x32_bf16 v[44:47], a[32:35], v[96:99], v[44:47]
    v_mfma_f32_16x16x32_bf16 v[48:51], a[36:39], v[96:99], v[48:51]
    v_mfma_f32_16x16x32_bf16 v[52:55], a[40:43], v[96:99], v[52:55]
    s_waitcnt vmcnt(11)
    v_mfma_f32_16x16x32_bf16 v[36:39], a[44:47], v[100:103], v[36:39]
    s_add_u32 s85, s85, 4096
    buffer_load_dwordx2 v[150:151], v9, s[12:15], s85 offen offset:0 sc1
    v_mfma_f32_16x16x32_bf16 v[40:43], a[48:51], v[100:103], v[40:43]
    v_mfma_f32_16x16x32_bf16 v[44:47], a[52:55], v[100:103], v[44:47]
    v_mfma_f32_16x16x32_bf16 v[48:51], a[56:59], v[100:103], v[48:51]
    v_mfma_f32_16x16x32_bf16 v[52:55], a[60:63], v[100:103], v[52:55]
    buffer_load_dwordx2 v[152:153], v9, s[12:15], s85 offen offset:512 sc1
    s_waitcnt vmcnt(12)
    v_mfma_f32_16x16x32_bf16 v[36:39], a[64:67], v[104:107], v[36:39]
    v_mfma_f32_16x16x32_bf16 v[40:43], a[68:71], v[104:107], v[40:43]
    v_mfma_f32_16x16x32_bf16 v[44:47], a[72:75], v[104:107], v[44:47]
    buffer_load_dwordx2 v[154:155], v9, s[12:15], s85 offen offset:1024 sc1
    v_mfma_f32_16x16x32_bf16 v[48:51], a[76:79], v[104:107], v[48:51]
    v_mfma_f32_16x16x32_bf16 v[52:55], a[80:83], v[104:107], v[52:55]
    s_waitcnt vmcnt(12)
    v_mfma_f32_16x16x32_bf16 v[36:39], a[84:87], v[108:111], v[36:39]
    v_mfma_f32_16x16x32_bf16 v[40:43], a[88:91], v[108:111], v[40:43]
    buffer_load_dwordx2 v[156:157], v9, s[12:15], s85 offen offset:1536 sc1
    v_mfma_f32_16x16x32_bf16 v[44:47], a[92:95], v[108:111], v[44:47]
    v_mfma_f32_16x16x32_bf16 v[48:51], a[96:99], v[108:111], v[48:51]
    v_mfma_f32_16x16x32_bf16 v[52:55], a[100:103], v[108:111], v[52:55]
    s_waitcnt vmcnt(12)
    v_mfma_f32_16x16x32_bf16 v[36:39], a[104:107], v[112:115], v[36:39]
    buffer_load_dwordx4 v[158:161], v8, s[12:15], s86 offen offset:0 sc1
    v_mfma_f32_16x16x32_bf16 v[40:43], a[108:111], v[112:115], v[40:43]
    v_mfma_f32_16x16x32_bf16 v[44:47], a[112:115], v[112:115], v[44:47]
    v_mfma_f32_16x16x32_bf16 v[48:51], a[116:119], v[112:115], v[48:51]
    v_mfma_f32_16x16x32_bf16 v[52:55], a[120:123], v[112:115], v[52:55]
    buffer_load_dwordx4 v[162:165], v8, s[12:15], s86 offen offset:1024 sc1
    s_waitcnt vmcnt(12)
    v_mfma_f32_16x16x32_bf16 v[36:39], a[124:127], v[116:119], v[36:39]
    v_mfma_f32_16x16x32_bf16 v[40:43], a[128:131], v[116:119], v[40:43]
    v_mfma_f32_16x16x32_bf16 v[44:47], a[132:135], v[116:119], v[44:47]
    buffer_load_dwordx4 v[166:169], v8, s[12:15], s86 offen offset:2048 sc1
    v_mfma_f32_16x16x32_bf16 v[48:51], a[136:139], v[116:119], v[48:51]
    v_mfma_f32_16x16x32_bf16 v[52:55], a[140:143], v[116:119], v[52:55]
    s_waitcnt vmcnt(11)
    v_mfma_f32_16x16x32_bf16 v[36:39], a[144:147], v[120:123], v[36:39]
    v_mfma_f32_16x16x32_bf16 v[40:43], a[148:151], v[120:123], v[40:43]
    buffer_load_dwordx4 v[170:173], v8, s[12:15], s86 offen offset:3072 sc1
    v_mfma_f32_16x16x32_bf16 v[44:47], a[152:155], v[120:123], v[44:47]
    v_mfma_f32_16x16x32_bf16 v[48:51], a[156:159], v[120:123], v[48:51]
    v_mfma_f32_16x16x32_bf16 v[52:55], a[160:163], v[120:123], v[52:55]
    s_waitcnt vmcnt(11)
    v_mfma_f32_16x16x32_bf16 v[56:59], a[164:167], v[124:127], 0
    s_add_u32 s86, s86, 4096
    buffer_load_dwordx2 v[174:175], v9, s[12:15], s86 offen offset:0 sc1
    v_mfma_f32_16x16x32_bf16 v[60:63], a[168:171], v[124:127], 0
    v_mfma_f32_16x16x32_bf16 v[64:67], a[172:175], v[124:127], 0
    v_mfma_f32_16x16x32_bf16 v[68:71], a[176:179], v[124:127], 0
    ds_write_b128 v11, v[36:39] offset:0
    v_mfma_f32_16x16x32_bf16 v[72:75], a[180:183], v[124:127], 0
    buffer_load_dwordx2 v[176:177], v9, s[12:15], s86 offen offset:512 sc1
    s_waitcnt vmcnt(12)
    v_mfma_f32_16x16x32_bf16 v[56:59], a[184:187], v[128:131], v[56:59]
    v_mfma_f32_16x16x32_bf16 v[60:63], a[188:191], v[128:131], v[60:63]
    ds_write_b128 v11, v[40:43] offset:1024
    v_mfma_f32_16x16x32_bf16 v[64:67], a[192:195], v[128:131], v[64:67]
    buffer_load_dwordx2 v[178:179], v9, s[12:15], s86 offen offset:1024 sc1
    v_mfma_f32_16x16x32_bf16 v[68:71], a[196:199], v[128:131], v[68:71]
    v_mfma_f32_16x16x32_bf16 v[72:75], a[200:203], v[128:131], v[72:75]
    ds_write_b128 v11, v[44:47] offset:2048
    s_waitcnt vmcnt(12)
    v_mfma_f32_16x16x32_bf16 v[56:59], a[204:207], v[142:145], v[56:59]
    v_mfma_f32_16x16x32_bf16 v[60:63], a[208:211], v[142:145], v[60:63]
    buffer_load_dwordx2 v[180:181], v9, s[12:15], s86 offen offset:1536 sc1
    v_mfma_f32_16x16x32_bf16 v[64:67], a[212:215], v[142:145], v[64:67]
    ds_write_b128 v11, v[48:51] offset:3072
    v_mfma_f32_16x16x32_bf16 v[68:71], a[216:219], v[142:145], v[68:71]
    v_mfma_f32_16x16x32_bf16 v[72:75], a[220:223], v[142:145], v[72:75]
    s_waitcnt vmcnt(12)
    v_mfma_f32_16x16x32_bf16 v[56:59], a[224:227], v[146:149], v[56:59]
    ds_write_b128 v11, v[52:55] offset:4096
    v_mfma_f32_16x16x32_bf16 v[60:63], a[228:231], v[146:149], v[60:63]
    buffer_load_dwordx4 v[76:79], v8, s[12:15], s87 offen offset:0 sc1
    v_mfma_f32_16x16x32_bf16 v[64:67], a[232:235], v[146:149], v[64:67]
    v_mfma_f32_16x16x32_bf16 v[68:71], a[236:239], v[146:149], v[68:71]
    v_mfma_f32_16x16x32_bf16 v[72:75], a[0:3], v[146:149], v[72:75]
    buffer_load_dwordx4 v[80:83], v8, s[12:15], s87 offen offset:1024 sc1
    s_waitcnt vmcnt(12)
    v_mfma_f32_16x16x32_bf16 v[56:59], a[4:7], v[150:153], v[56:59]
    v_mfma_f32_16x16x32_bf16 v[60:63], a[8:11], v[150:153], v[60:63]
    v_mfma_f32_16x16x32_bf16 v[64:67], a[12:15], v[150:153], v[64:67]
    buffer_load_dwordx4 v[84:87], v8, s[12:15], s87 offen offset:2048 sc1
    v_mfma_f32_16x16x32_bf16 v[68:71], a[16:19], v[150:153], v[68:71]
    v_mfma_f32_16x16x32_bf16 v[72:75], a[20:23], v[150:153], v[72:75]
    s_waitcnt vmcnt(11)
    v_mfma_f32_16x16x32_bf16 v[56:59], a[24:27], v[154:157], v[56:59]
    v_mfma_f32_16x16x32_bf16 v[60:63], a[28:31], v[154:157], v[60:63]
    buffer_load_dwordx4 v[88:91], v8, s[12:15], s87 offen offset:3072 sc1
    v_mfma_f32_16x16x32_bf16 v[64:67], a[32:35], v[154:157], v[64:67]
    v_mfma_f32_16x16x32_bf16 v[68:71], a[36:39], v[154:157], v[68:71]
    v_mfma_f32_16x16x32_bf16 v[72:75], a[40:43], v[154:157], v[72:75]
    s_waitcnt vmcnt(11)
    v_mfma_f32_16x16x32_bf16 v[56:59], a[44:47], v[158:161], v[56:59]
    s_add_u32 s87, s87, 4096
    buffer_load_dwordx2 v[92:93], v9, s[12:15], s87 offen offset:0 sc1
    v_mfma_f32_16x16x32_bf16 v[60:63], a[48:51], v[158:161], v[60:63]
    v_mfma_f32_16x16x32_bf16 v[64:67], a[52:55], v[158:161], v[64:67]
    v_mfma_f32_16x16x32_bf16 v[68:71], a[56:59], v[158:161], v[68:71]
    v_mfma_f32_16x16x32_bf16 v[72:75], a[60:63], v[158:161], v[72:75]
    buffer_load_dwordx2 v[94:95], v9, s[12:15], s87 offen offset:512 sc1
    s_waitcnt vmcnt(12)
    v_mfma_f32_16x16x32_bf16 v[56:59], a[64:67], v[162:165], v[56:59]
    v_mfma_f32_16x16x32_bf16 v[60:63], a[68:71], v[162:165], v[60:63]
    v_mfma_f32_16x16x32_bf16 v[64:67], a[72:75], v[162:165], v[64:67]
    buffer_load_dwordx2 v[96:97], v9, s[12:15], s87 offen offset:1024 sc1
    v_mfma_f32_16x16x32_bf16 v[68:71], a[76:79], v[162:165], v[68:71]
    v_mfma_f32_16x16x32_bf16 v[72:75], a[80:83], v[162:165], v[72:75]
    s_waitcnt vmcnt(12)
    v_mfma_f32_16x16x32_bf16 v[56:59], a[84:87], v[166:169], v[56:59]
    v_mfma_f32_16x16x32_bf16 v[60:63], a[88:91], v[166:169], v[60:63]
    buffer_load_dwordx2 v[98:99], v9, s[12:15], s87 offen offset:1536 sc1
    v_mfma_f32_16x16x32_bf16 v[64:67], a[92:95], v[166:169], v[64:67]
    v_mfma_f32_16x16x32_bf16 v[68:71], a[96:99], v[166:169], v[68:71]
    v_mfma_f32_16x16x32_bf16 v[72:75], a[100:103], v[166:169], v[72:75]
    s_waitcnt vmcnt(12)
    v_mfma_f32_16x16x32_bf16 v[56:59], a[104:107], v[170:173], v[56:59]
    buffer_load_dwordx4 v[100:103], v8, s[12:15], s88 offen offset:0 sc1
    v_mfma_f32_16x16x32_bf16 v[60:63], a[108:111], v[170:173], v[60:63]
    v_mfma_f32_16x16x32_bf16 v[64:67], a[112:115], v[170:173], v[64:67]
    v_mfma_f32_16x16x32_bf16 v[68:71], a[116:119], v[170:173], v[68:71]
    v_mfma_f32_16x16x32_bf16 v[72:75], a[120:123], v[170:173], v[72:75]
    buffer_load_dwordx4 v[104:107], v8, s[12:15], s88 offen offset:1024 sc1
    s_waitcnt vmcnt(12)
    v_mfma_f32_16x16x32_bf16 v[56:59], a[124:127], v[174:177], v[56:59]
    v_mfma_f32_16x16x32_bf16 v[60:63], a[128:131], v[174:177], v[60:63]
    v_mfma_f32_16x16x32_bf16 v[64:67], a[132:135], v[174:177], v[64:67]
    buffer_load_dwordx4 v[108:111], v8, s[12:15], s88 offen offset:2048 sc1
    v_mfma_f32_16x16x32_bf16 v[68:71], a[136:139], v[174:177], v[68:71]
    v_mfma_f32_16x16x32_bf16 v[72:75], a[140:143], v[174:177], v[72:75]
    s_waitcnt vmcnt(11)
    v_mfma_f32_16x16x32_bf16 v[56:59], a[144:147], v[178:181], v[56:59]
    v_mfma_f32_16x16x32_bf16 v[60:63], a[148:151], v[178:181], v[60:63]
    buffer_load_dwordx4 v[112:115], v8, s[12:15], s88 offen offset:3072 sc1
    v_mfma_f32_16x16x32_bf16 v[64:67], a[152:155], v[178:181], v[64:67]
    v_mfma_f32_16x16x32_bf16 v[68:71], a[156:159], v[178:181], v[68:71]
    v_mfma_f32_16x16x32_bf16 v[72:75], a[160:163], v[178:181], v[72:75]
    s_waitcnt vmcnt(11)
    v_mfma_f32_16x16x32_bf16 v[36:39], a[164:167], v[76:79], 0
    s_add_u32 s88, s88, 4096
    buffer_load_dwordx2 v[116:117], v9, s[12:15], s88 offen offset:0 sc1
    v_mfma_f32_16x16x32_bf16 v[40:43], a[168:171], v[76:79], 0
    v_mfma_f32_16x16x32_bf16 v[44:47], a[172:175], v[76:79], 0
    v_mfma_f32_16x16x32_bf16 v[48:51], a[176:179], v[76:79], 0
    ds_write_b128 v12, v[56:59] offset:0
    v_mfma_f32_16x16x32_bf16 v[52:55], a[180:183], v[76:79], 0
    buffer_load_dwordx2 v[118:119], v9, s[12:15], s88 offen offset:512 sc1
    s_waitcnt vmcnt(12)
    v_mfma_f32_16x16x32_bf16 v[36:39], a[184:187], v[80:83], v[36:39]
    v_mfma_f32_16x16x32_bf16 v[40:43], a[188:191], v[80:83], v[40:43]
    ds_write_b128 v12, v[60:63] offset:1024
    v_mfma_f32_16x16x32_bf16 v[44:47], a[192:195], v[80:83], v[44:47]
    buffer_load_dwordx2 v[120:121], v9, s[12:15], s88 offen offset:1024 sc1
    v_mfma_f32_16x16x32_bf16 v[48:51], a[196:199], v[80:83], v[48:51]
    v_mfma_f32_16x16x32_bf16 v[52:55], a[200:203], v[80:83], v[52:55]
    ds_write_b128 v12, v[64:67] offset:2048
    s_waitcnt vmcnt(12)
    v_mfma_f32_16x16x32_bf16 v[36:39], a[204:207], v[84:87], v[36:39]
    v_mfma_f32_16x16x32_bf16 v[40:43], a[208:211], v[84:87], v[40:43]
    buffer_load_dwordx2 v[122:123], v9, s[12:15], s88 offen offset:1536 sc1
    v_mfma_f32_16x16x32_bf16 v[44:47], a[212:215], v[84:87], v[44:47]
    ds_write_b128 v12, v[68:71] offset:3072
    v_mfma_f32_16x16x32_bf16 v[48:51], a[216:219], v[84:87], v[48:51]
    v_mfma_f32_16x16x32_bf16 v[52:55], a[220:223], v[84:87], v[52:55]
    s_waitcnt vmcnt(12)
    v_mfma_f32_16x16x32_bf16 v[36:39], a[224:227], v[88:91], v[36:39]
    ds_write_b128 v12, v[72:75] offset:4096
    v_mfma_f32_16x16x32_bf16 v[40:43], a[228:231], v[88:91], v[40:43]
    buffer_load_dwordx4 v[124:127], v8, s[12:15], s89 offen offset:0 sc1
    v_mfma_f32_16x16x32_bf16 v[44:47], a[232:235], v[88:91], v[44:47]
    v_mfma_f32_16x16x32_bf16 v[48:51], a[236:239], v[88:91], v[48:51]
    v_mfma_f32_16x16x32_bf16 v[52:55], a[0:3], v[88:91], v[52:55]
    buffer_load_dwordx4 v[128:131], v8, s[12:15], s89 offen offset:1024 sc1
    s_waitcnt vmcnt(12)
    v_mfma_f32_16x16x32_bf16 v[36:39], a[4:7], v[92:95], v[36:39]
    v_mfma_f32_16x16x32_bf16 v[40:43], a[8:11], v[92:95], v[40:43]
    v_mfma_f32_16x16x32_bf16 v[44:47], a[12:15], v[92:95], v[44:47]
    buffer_load_dwordx4 v[142:145], v8, s[12:15], s89 offen offset:2048 sc1
    v_mfma_f32_16x16x32_bf16 v[48:51], a[16:19], v[92:95], v[48:51]
    v_mfma_f32_16x16x32_bf16 v[52:55], a[20:23], v[92:95], v[52:55]
    s_waitcnt vmcnt(11)
    v_mfma_f32_16x16x32_bf16 v[36:39], a[24:27], v[96:99], v[36:39]
    v_mfma_f32_16x16x32_bf16 v[40:43], a[28:31], v[96:99], v[40:43]
    buffer_load_dwordx4 v[146:149], v8, s[12:15], s89 offen offset:3072 sc1
    v_mfma_f32_16x16x32_bf16 v[44:47], a[32:35], v[96:99], v[44:47]
    v_mfma_f32_16x16x32_bf16 v[48:51], a[36:39], v[96:99], v[48:51]
    v_mfma_f32_16x16x32_bf16 v[52:55], a[40:43], v[96:99], v[52:55]
    s_waitcnt vmcnt(11)
    v_mfma_f32_16x16x32_bf16 v[36:39], a[44:47], v[100:103], v[36:39]
    s_add_u32 s89, s89, 4096
    buffer_load_dwordx2 v[150:151], v9, s[12:15], s89 offen offset:0 sc1
    v_mfma_f32_16x16x32_bf16 v[40:43], a[48:51], v[100:103], v[40:43]
    v_mfma_f32_16x16x32_bf16 v[44:47], a[52:55], v[100:103], v[44:47]
    v_mfma_f32_16x16x32_bf16 v[48:51], a[56:59], v[100:103], v[48:51]
    v_mfma_f32_16x16x32_bf16 v[52:55], a[60:63], v[100:103], v[52:55]
    buffer_load_dwordx2 v[152:153], v9, s[12:15], s89 offen offset:512 sc1
    s_waitcnt vmcnt(12)
    v_mfma_f32_16x16x32_bf16 v[36:39], a[64:67], v[104:107], v[36:39]
    v_mfma_f32_16x16x32_bf16 v[40:43], a[68:71], v[104:107], v[40:43]
    v_mfma_f32_16x16x32_bf16 v[44:47], a[72:75], v[104:107], v[44:47]
    buffer_load_dwordx2 v[154:155], v9, s[12:15], s89 offen offset:1024 sc1
    v_mfma_f32_16x16x32_bf16 v[48:51], a[76:79], v[104:107], v[48:51]
    v_mfma_f32_16x16x32_bf16 v[52:55], a[80:83], v[104:107], v[52:55]
    s_waitcnt vmcnt(12)
    v_mfma_f32_16x16x32_bf16 v[36:39], a[84:87], v[108:111], v[36:39]
    v_mfma_f32_16x16x32_bf16 v[40:43], a[88:91], v[108:111], v[40:43]
    buffer_load_dwordx2 v[156:157], v9, s[12:15], s89 offen offset:1536 sc1
    v_mfma_f32_16x16x32_bf16 v[44:47], a[92:95], v[108:111], v[44:47]
    v_mfma_f32_16x16x32_bf16 v[48:51], a[96:99], v[108:111], v[48:51]
    v_mfma_f32_16x16x32_bf16 v[52:55], a[100:103], v[108:111], v[52:55]
    s_waitcnt vmcnt(12)
    v_mfma_f32_16x16x32_bf16 v[36:39], a[104:107], v[112:115], v[36:39]
    buffer_load_dwordx4 v[158:161], v8, s[12:15], s90 offen offset:0 sc1
    v_mfma_f32_16x16x32_bf16 v[40:43], a[108:111], v[112:115], v[40:43]
    v_mfma_f32_16x16x32_bf16 v[44:47], a[112:115], v[112:115], v[44:47]
    v_mfma_f32_16x16x32_bf16 v[48:51], a[116:119], v[112:115], v[48:51]
    v_mfma_f32_16x16x32_bf16 v[52:55], a[120:123], v[112:115], v[52:55]
    buffer_load_dwordx4 v[162:165], v8, s[12:15], s90 offen offset:1024 sc1
    s_waitcnt vmcnt(12)
    v_mfma_f32_16x16x32_bf16 v[36:39], a[124:127], v[116:119], v[36:39]
    v_mfma_f32_16x16x32_bf16 v[40:43], a[128:131], v[116:119], v[40:43]
    v_mfma_f32_16x16x32_bf16 v[44:47], a[132:135], v[116:119], v[44:47]
    buffer_load_dwordx4 v[166:169], v8, s[12:15], s90 offen offset:2048 sc1
    v_mfma_f32_16x16x32_bf16 v[48:51], a[136:139], v[116:119], v[48:51]
    v_mfma_f32_16x16x32_bf16 v[52:55], a[140:143], v[116:119], v[52:55]
    s_waitcnt vmcnt(11)
    v_mfma_f32_16x16x32_bf16 v[36:39], a[144:147], v[120:123], v[36:39]
    v_mfma_f32_16x16x32_bf16 v[40:43], a[148:151], v[120:123], v[40:43]
    buffer_load_dwordx4 v[170:173], v8, s[12:15], s90 offen offset:3072 sc1
    v_mfma_f32_16x16x32_bf16 v[44:47], a[152:155], v[120:123], v[44:47]
    v_mfma_f32_16x16x32_bf16 v[48:51], a[156:159], v[120:123], v[48:51]
    v_mfma_f32_16x16x32_bf16 v[52:55], a[160:163], v[120:123], v[52:55]
    s_waitcnt vmcnt(11)
    v_mfma_f32_16x16x32_bf16 v[16:19], a[164:167], v[124:127], v[16:19]
    s_add_u32 s90, s90, 4096
    buffer_load_dwordx2 v[174:175], v9, s[12:15], s90 offen offset:0 sc1
    v_mfma_f32_16x16x32_bf16 v[20:23], a[168:171], v[124:127], v[20:23]
    v_mfma_f32_16x16x32_bf16 v[24:27], a[172:175], v[124:127], v[24:27]
    v_mfma_f32_16x16x32_bf16 v[28:31], a[176:179], v[124:127], v[28:31]
    ds_write_b128 v13, v[36:39] offset:0
    v_mfma_f32_16x16x32_bf16 v[32:35], a[180:183], v[124:127], v[32:35]
    buffer_load_dwordx2 v[176:177], v9, s[12:15], s90 offen offset:512 sc1
    s_waitcnt vmcnt(12)
    v_mfma_f32_16x16x32_bf16 v[16:19], a[184:187], v[128:131], v[16:19]
    v_mfma_f32_16x16x32_bf16 v[20:23], a[188:191], v[128:131], v[20:23]
    ds_write_b128 v13, v[40:43] offset:1024
    v_mfma_f32_16x16x32_bf16 v[24:27], a[192:195], v[128:131], v[24:27]
    buffer_load_dwordx2 v[178:179], v9, s[12:15], s90 offen offset:1024 sc1
    v_mfma_f32_16x16x32_bf16 v[28:31], a[196:199], v[128:131], v[28:31]
    v_mfma_f32_16x16x32_bf16 v[32:35], a[200:203], v[128:131], v[32:35]
    ds_write_b128 v13, v[44:47] offset:2048
    s_waitcnt vmcnt(12)
    v_mfma_f32_16x16x32_bf16 v[16:19], a[204:207], v[142:145], v[16:19]
    v_mfma_f32_16x16x32_bf16 v[20:23], a[208:211], v[142:145], v[20:23]
    buffer_load_dwordx2 v[180:181], v9, s[12:15], s90 offen offset:1536 sc1
    v_mfma_f32_16x16x32_bf16 v[24:27], a[212:215], v[142:145], v[24:27]
    ds_write_b128 v13, v[48:51] offset:3072
    v_mfma_f32_16x16x32_bf16 v[28:31], a[216:219], v[142:145], v[28:31]
    v_mfma_f32_16x16x32_bf16 v[32:35], a[220:223], v[142:145], v[32:35]
    s_waitcnt vmcnt(12)
    v_mfma_f32_16x16x32_bf16 v[16:19], a[224:227], v[146:149], v[16:19]
    ds_write_b128 v13, v[52:55] offset:4096
    v_mfma_f32_16x16x32_bf16 v[20:23], a[228:231], v[146:149], v[20:23]
    v_mfma_f32_16x16x32_bf16 v[24:27], a[232:235], v[146:149], v[24:27]
    v_mfma_f32_16x16x32_bf16 v[28:31], a[236:239], v[146:149], v[28:31]
    v_mfma_f32_16x16x32_bf16 v[32:35], a[0:3], v[146:149], v[32:35]
    s_waitcnt vmcnt(10)
    v_mfma_f32_16x16x32_bf16 v[16:19], a[4:7], v[150:153], v[16:19]
    v_mfma_f32_16x16x32_bf16 v[20:23], a[8:11], v[150:153], v[20:23]
    v_mfma_f32_16x16x32_bf16 v[24:27], a[12:15], v[150:153], v[24:27]
    v_mfma_f32_16x16x32_bf16 v[28:31], a[16:19], v[150:153], v[28:31]
    v_mfma_f32_16x16x32_bf16 v[32:35], a[20:23], v[150:153], v[32:35]
    s_waitcnt lgkmcnt(0)
    s_barrier
    s_waitcnt vmcnt(8)
    v_mfma_f32_16x16x32_bf16 v[16:19], a[24:27], v[154:157], v[16:19]
    ds_read_b128 v[76:79], v14 offset:0
    ds_read_b128 v[80:83], v14 offset:1024
    v_mfma_f32_16x16x32_bf16 v[20:23], a[28:31], v[154:157], v[20:23]
    ds_read_b128 v[84:87], v14 offset:2048
    ds_read_b128 v[88:91], v14 offset:3072
    v_mfma_f32_16x16x32_bf16 v[24:27], a[32:35], v[154:157], v[24:27]
    ds_read_b128 v[92:95], v14 offset:4096
    ds_read_b128 v[96:99], v14 offset:5120
    v_mfma_f32_16x16x32_bf16 v[28:31], a[36:39], v[154:157], v[28:31]
    ds_read_b128 v[100:103], v14 offset:6144
    ds_read_b128 v[104:107], v14 offset:7168
    v_mfma_f32_16x16x32_bf16 v[32:35], a[40:43], v[154:157], v[32:35]
    ds_read_b128 v[108:111], v14 offset:8192
    ds_read_b128 v[112:115], v14 offset:9216
    s_waitcnt vmcnt(7)
    v_mfma_f32_16x16x32_bf16 v[16:19], a[44:47], v[158:161], v[16:19]
    ds_read_b128 v[116:119], v14 offset:10240
    ds_read_b128 v[120:123], v14 offset:11264
    v_mfma_f32_16x16x32_bf16 v[20:23], a[48:51], v[158:161], v[20:23]
    ds_read_b128 v[56:59], v14 offset:12288
    ds_read_b128 v[60:63], v14 offset:13312
    v_mfma_f32_16x16x32_bf16 v[24:27], a[52:55], v[158:161], v[24:27]
    ds_read_b128 v[64:67], v14 offset:14336
    s_waitcnt lgkmcnt(9)
    v_add_f32 v76, v76, v96
    v_mfma_f32_16x16x32_bf16 v[28:31], a[56:59], v[158:161], v[28:31]
    v_add_f32 v77, v77, v97
    v_add_f32 v78, v78, v98
    v_mfma_f32_16x16x32_bf16 v[32:35], a[60:63], v[158:161], v[32:35]
    v_add_f32 v79, v79, v99
    s_waitcnt lgkmcnt(8)
    v_add_f32 v80, v80, v100
    s_waitcnt vmcnt(6)
    v_mfma_f32_16x16x32_bf16 v[16:19], a[64:67], v[162:165], v[16:19]
    v_add_f32 v81, v81, v101
    v_add_f32 v82, v82, v102
    v_mfma_f32_16x16x32_bf16 v[20:23], a[68:71], v[162:165], v[20:23]
    v_add_f32 v83, v83, v103
    s_waitcnt lgkmcnt(7)
    v_add_f32 v84, v84, v104
    v_mfma_f32_16x16x32_bf16 v[24:27], a[72:75], v[162:165], v[24:27]
    v_add_f32 v85, v85, v105
    v_add_f32 v86, v86, v106
    v_mfma_f32_16x16x32_bf16 v[28:31], a[76:79], v[162:165], v[28:31]
    v_add_f32 v87, v87, v107
    s_waitcnt lgkmcnt(6)
    v_add_f32 v88, v88, v108
    v_mfma_f32_16x16x32_bf16 v[32:35], a[80:83], v[162:165], v[32:35]
    v_add_f32 v89, v89, v109
    v_add_f32 v90, v90, v110
    s_waitcnt vmcnt(5)
    v_mfma_f32_16x16x32_bf16 v[16:19], a[84:87], v[166:169], v[16:19]
    v_add_f32 v91, v91, v111
    s_waitcnt lgkmcnt(5)
    v_add_f32 v92, v92, v112
    v_mfma_f32_16x16x32_bf16 v[20:23], a[88:91], v[166:169], v[20:23]
    v_add_f32 v93, v93, v113
    v_add_f32 v94, v94, v114
    v_mfma_f32_16x16x32_bf16 v[24:27], a[92:95], v[166:169], v[24:27]
    v_add_f32 v95, v95, v115
    s_waitcnt lgkmcnt(4)
    v_add_f32 v76, v76, v116
    v_mfma_f32_16x16x32_bf16 v[28:31], a[96:99], v[166:169], v[28:31]
    v_add_f32 v77, v77, v117
    v_add_f32 v78, v78, v118
    v_mfma_f32_16x16x32_bf16 v[32:35], a[100:103], v[166:169], v[32:35]
    v_add_f32 v79, v79, v119
    s_waitcnt lgkmcnt(3)
    v_add_f32 v80, v80, v120
    s_waitcnt vmcnt(4)
    v_mfma_f32_16x16x32_bf16 v[16:19], a[104:107], v[170:173], v[16:19]
    v_add_f32 v81, v81, v121
    v_add_f32 v82, v82, v122
    v_mfma_f32_16x16x32_bf16 v[20:23], a[108:111], v[170:173], v[20:23]
    v_add_f32 v83, v83, v123
    s_waitcnt lgkmcnt(2)
    v_add_f32 v84, v84, v56
    v_mfma_f32_16x16x32_bf16 v[24:27], a[112:115], v[170:173], v[24:27]
    v_add_f32 v85, v85, v57
    v_add_f32 v86, v86, v58
    v_mfma_f32_16x16x32_bf16 v[28:31], a[116:119], v[170:173], v[28:31]
    v_add_f32 v87, v87, v59
    s_waitcnt lgkmcnt(1)
    v_add_f32 v88, v88, v60
    v_mfma_f32_16x16x32_bf16 v[32:35], a[120:123], v[170:173], v[32:35]
    v_add_f32 v89, v89, v61
    v_add_f32 v90, v90, v62
    s_waitcnt vmcnt(2)
    v_mfma_f32_16x16x32_bf16 v[16:19], a[124:127], v[174:177], v[16:19]
    v_add_f32 v91, v91, v63
    s_waitcnt lgkmcnt(0)
    v_add_f32 v92, v92, v64
    v_mfma_f32_16x16x32_bf16 v[20:23], a[128:131], v[174:177], v[20:23]
    v_add_f32 v93, v93, v65
    v_add_f32 v94, v94, v66
    v_mfma_f32_16x16x32_bf16 v[24:27], a[132:135], v[174:177], v[24:27]
    v_add_f32 v95, v95, v67
    v_mfma_f32_16x16x32_bf16 v[28:31], a[136:139], v[174:177], v[28:31]
    v_mfma_f32_16x16x32_bf16 v[32:35], a[140:143], v[174:177], v[32:35]
    s_waitcnt vmcnt(0)
    v_mfma_f32_16x16x32_bf16 v[16:19], a[144:147], v[178:181], v[16:19]
    v_mfma_f32_16x16x32_bf16 v[20:23], a[148:151], v[178:181], v[20:23]
    v_mfma_f32_16x16x32_bf16 v[24:27], a[152:155], v[178:181], v[24:27]
    v_mfma_f32_16x16x32_bf16 v[28:31], a[156:159], v[178:181], v[28:31]
    v_mfma_f32_16x16x32_bf16 v[32:35], a[160:163], v[178:181], v[32:35]
    s_nop 3
    v_pk_add_f32 v[16:17], v[16:17], v[76:77]
    v_pk_add_f32 v[18:19], v[18:19], v[78:79]
    v_pk_add_f32 v[20:21], v[20:21], v[80:81]
    v_pk_add_f32 v[22:23], v[22:23], v[82:83]
    v_pk_add_f32 v[24:25], v[24:25], v[84:85]
    v_pk_add_f32 v[26:27], v[26:27], v[86:87]
    v_pk_add_f32 v[28:29], v[28:29], v[88:89]
    v_pk_add_f32 v[30:31], v[30:31], v[90:91]
    v_pk_add_f32 v[32:33], v[32:33], v[92:93]
    v_pk_add_f32 v[34:35], v[34:35], v[94:95]
    v_pk_mul_f32 v[16:17], v[16:17], v[238:239] op_sel_hi:[1,0]
    v_cvt_pk_bf16_f32 v132, v16, v17
    v_pk_mul_f32 v[18:19], v[18:19], v[238:239] op_sel_hi:[1,0]
    v_cvt_pk_bf16_f32 v133, v18, v19
    v_pk_mul_f32 v[20:21], v[20:21], v[238:239] op_sel_hi:[1,0]
    v_cvt_pk_bf16_f32 v134, v20, v21
    v_pk_mul_f32 v[22:23], v[22:23], v[238:239] op_sel_hi:[1,0]
    v_cvt_pk_bf16_f32 v135, v22, v23
    v_pk_mul_f32 v[24:25], v[24:25], v[238:239] op_sel_hi:[1,0]
    v_cvt_pk_bf16_f32 v136, v24, v25
    v_pk_mul_f32 v[26:27], v[26:27], v[238:239] op_sel_hi:[1,0]
    v_cvt_pk_bf16_f32 v137, v26, v27
    v_pk_mul_f32 v[28:29], v[28:29], v[238:239] op_sel_hi:[1,0]
    v_cvt_pk_bf16_f32 v138, v28, v29
    v_pk_mul_f32 v[30:31], v[30:31], v[238:239] op_sel_hi:[1,0]
    v_cvt_pk_bf16_f32 v139, v30, v31
    v_pk_mul_f32 v[32:33], v[32:33], v[238:239] op_sel_hi:[1,0]
    v_cvt_pk_bf16_f32 v140, v32, v33
    v_pk_mul_f32 v[34:35], v[34:35], v[238:239] op_sel_hi:[1,0]
    v_cvt_pk_bf16_f32 v141, v34, v35
    buffer_store_dwordx4 v[132:135], v4, s[20:23], s74 offen
    buffer_store_dwordx4 v[136:139], v4, s[20:23], s74 offen offset:16
    buffer_store_dwordx2 v[140:141], v4, s[20:23], s74 offen offset:32
    s_or_b32 s74, s2, s3
    s_cmp_lg_u32 s74, 0
    s_cbranch_scc1 L_ep_25
    s_mov_b32 s74, 0xc48000
    s_mov_b64 exec, 1
    buffer_store_dword v7, v6, s[12:15], s74 offen sc1
    s_mov_b64 exec, -1
L_ep_25:
L_end:
    s_endpgm
.section .rodata,"a"
.p2align 6
.amdhsa_kernel sequential_preLN__linear_kernel_hedgehog__dense_activation_relu__prompt_kernel
  .amdhsa_next_free_vgpr 512
  .amdhsa_next_free_sgpr 102
  .amdhsa_accum_offset 256
  .amdhsa_group_segment_fixed_size 0
  .amdhsa_kernarg_size 80
  .amdhsa_user_sgpr_count 2
  .amdhsa_user_sgpr_kernarg_segment_ptr 1
  .amdhsa_system_sgpr_workgroup_id_x 1
.end_amdhsa_kernel
```
